```python
import torch

def _softmax(x, axis=-1):
    return torch.softmax(x, dim=axis)
def _gelu(x):
    return torch.nn.functional.gelu(x, approximate="tanh")
def _silu(x):
    return torch.nn.functional.silu(x)
def _sigmoid(x):
    return torch.sigmoid(x)
def _layernorm(x, axis=-1, eps=1e-5):
    m = x.mean(dim=axis, keepdim=True)
    v = x.var(dim=axis, keepdim=True, unbiased=False)
    return (x - m) / torch.sqrt(v + eps)
def _scatter_add(tgt, idx, src, axis=0):
    return tgt.clone().index_add_(axis, idx, src)
def _segment_sum(src, seg, n):
    out = torch.zeros((n,) + src.shape[1:], dtype=src.dtype)
    return out.index_add_(0, seg, src)
def _pad(x, pw):
    flat = tuple(v for pair in reversed(pw) for v in pair)
    return torch.nn.functional.pad(x, flat)

kernel_name = 'gated_mix__mha_block_cached__swiglu_ffn__decode'

def setup_inputs():

    _w = (lambda a: (lambda t: t.to(torch.bfloat16) if t.is_floating_point() else t)(torch.as_tensor(a)))
    def _A_setup():
        B, Sq, D = 2, 1, 640
        H, Sk, Dh = 32, 8192, 128
        return {
            "x": _w((lambda *s: torch.randn(*s, dtype=torch.bfloat16) * 0.05)(B, Sq, D)),
            "k_cache": _w((lambda *s: torch.randn(*s, dtype=torch.bfloat16) * 6.4)(B, H, Sk, Dh)),
            "v_cache": _w((lambda *s: torch.randn(*s, dtype=torch.bfloat16) * 0.2)(B, H, Sk, Dh)),
            "wq": _w((lambda *s: torch.randn(*s, dtype=torch.bfloat16) * 6.4)(D, H * Dh) * (D ** -0.5)),
            "wo": _w((lambda *s: torch.randn(*s, dtype=torch.bfloat16) * 0.2)(H * Dh, D) * ((H * Dh) ** -0.5)),
        }
    _A_in = _A_setup()

    def _B_setup():
        B, S, D, F = 2, 1, 640, 1728
        return {
            "x": _w((lambda *s: torch.randn(*s, dtype=torch.bfloat16) * 0.05)(B, S, D)),
            "w_gate": _w((lambda *s: torch.randn(*s, dtype=torch.bfloat16) * 0.05)(D, F)),
            "w_up": _w((lambda *s: torch.randn(*s, dtype=torch.bfloat16) * 0.05)(D, F)),
            "w_down": _w((lambda *s: torch.randn(*s, dtype=torch.bfloat16) * 0.05)(F, D)),
        }
    _B_in = _B_setup()

    return {
        "A_x": _A_in["x"],
        "A_k_cache": _A_in["k_cache"],
        "A_v_cache": _A_in["v_cache"],
        "A_wq": _A_in["wq"],
        "A_wo": _A_in["wo"],
        "B_x": _B_in["x"],
        "B_w_gate": _B_in["w_gate"],
        "B_w_up": _B_in["w_up"],
        "B_w_down": _B_in["w_down"],
        "gate_w": _w((lambda *s: torch.randn(*s, dtype=torch.bfloat16) * 0.05)(640) * 16.0),
    }

def reference(A_x, A_k_cache, A_v_cache, A_wq, A_wo, B_x, B_w_gate, B_w_up, B_w_down, gate_w):
    def _A_ref(x, k_cache, v_cache, wq, wo):
        B, Sq, D = x.shape
        H, Dh = 32, 128
        q = (lambda x, *d: x.permute(*d))((x @ wq).reshape(B, Sq, H, Dh), 0, 2, 1, 3)
        scores = torch.einsum("bhqd,bhkd->bhqk", q, k_cache) * (Dh ** -0.5)
        p = _softmax(scores, axis=-1)
        o = torch.einsum("bhqk,bhkd->bhqd", p, v_cache)
        return (lambda x, *d: x.permute(*d))(o, 0, 2, 1, 3).reshape(B, Sq, H * Dh) @ wo

    def _B_ref(x, w_gate, w_up, w_down):
        g = _silu(x @ w_gate)
        u = x @ w_up
        return (g * u) @ w_down

    x = A_x
    g = _sigmoid((x * gate_w).sum(-1, keepdims=True))
    a = _A_ref(x, A_k_cache, A_v_cache, A_wq, A_wo)
    b = _B_ref(x, B_w_gate, B_w_up, B_w_down)
    return g * a + (1 - g) * b
```

```asm
; @launch grid=(256,1,1) block=(512,1,1) lds=16384
.amdgcn_target "amdgcn-amd-amdhsa--gfx950"
.text
.globl gated_mix__mha_block_cached__swiglu_ffn__decode_kernel
.p2align 8
.type gated_mix__mha_block_cached__swiglu_ffn__decode_kernel,@function
gated_mix__mha_block_cached__swiglu_ffn__decode_kernel:
    s_cmp_ge_u32 s2, 256
    s_cbranch_scc1 L_end
    s_load_dwordx16 s[4:19], s[0:1], 0
    s_load_dwordx8 s[20:27], s[0:1], 64
    s_load_dwordx2 s[28:29], s[0:1], 96
    v_lshrrev_b32 v2, 6, v0
    v_and_b32 v1, 63, v0
    s_and_b32 s54, s2, 7
    v_readfirstlane_b32 s3, v2
    s_lshr_b32 s55, s2, 3
    s_and_b32 s30, s55, 3
    s_lshl_b32 s56, s54, 2
    s_add_u32 s30, s30, s56
    s_bfe_u32 s31, s55, 0x10002
    s_lshr_b32 s32, s55, 3
    s_lshl_b32 s33, s31, 5
    s_add_u32 s33, s33, s30
    s_lshl_b32 s34, s33, 2
    s_add_u32 s34, s34, s32
    v_and_b32 v3, 15, v1
    v_lshrrev_b32 v2, 4, v1
    s_cmp_ge_u32 s3, 4
    s_cbranch_scc1 L_stream
    s_lshl_b32 s57, s31, 2
    s_add_u32 s57, s57, s32
    s_lshl_b32 s60, s30, 3
    s_add_u32 s60, s60, s57
    s_cmp_eq_u32 s3, 0
    s_cbranch_scc0 L_a_notw0
    s_mul_i32 s57, s57, 80
    v_mad_u32_u24 v4, v2, 20, s57
    v_lshrrev_b32 v6, 3, v3
    v_mul_u32_u24 v6, 1280, v6
    v_lshl_add_u32 v5, v4, 1, v6
    s_lshl_b32 s57, s30, 8
    v_lshlrev_b32 v4, 13, v4
    v_lshl_add_u32 v7, v3, 4, s57
    v_add_u32 v4, v4, v7
    s_mov_b32 s48, 0
    s_movk_i32 s49, 0x2000
    v_mov_b32 v55, v5
    v_lshrrev_b32 v7, 1, v2
    v_lshlrev_b32 v7, 9, v7
    v_and_b32 v5, 1, v2
    v_lshl_add_u32 v7, v5, 4, v7
    v_lshl_add_u32 v7, v3, 5, v7
    v_mov_b32 v5, v55
    s_lshl_b32 s58, s60, 10
    s_add_u32 s58, s58, 663552
    s_lshl_b32 s56, s30, 13
    s_lshl_b32 s57, s31, 9
    s_add_u32 s56, s56, s57
    s_add_u32 s56, s56, 663552
    s_add_u32 s57, s56, 4096
    v_lshlrev_b32 v6, 3, v1
    s_waitcnt lgkmcnt(0)
    s_mov_b32 s40, s28
    s_mov_b32 s41, s29
    s_mov_b32 s42, 0x1ba000
    s_mov_b32 s43, 0x20000
    buffer_load_dwordx4 v[28:31], v7, s[40:43], s58 offen sc1
    buffer_load_dwordx2 v[80:81], v6, s[40:43], s56 offen offset:0 sc1
    buffer_load_dwordx2 v[82:83], v6, s[40:43], s56 offen offset:1024 sc1
    buffer_load_dwordx2 v[84:85], v6, s[40:43], s56 offen offset:2048 sc1
    buffer_load_dwordx2 v[86:87], v6, s[40:43], s56 offen offset:3072 sc1
    buffer_load_dwordx2 v[88:89], v6, s[40:43], s57 offen offset:0 sc1
    buffer_load_dwordx2 v[90:91], v6, s[40:43], s57 offen offset:1024 sc1
    buffer_load_dwordx2 v[92:93], v6, s[40:43], s57 offen offset:2048 sc1
    buffer_load_dwordx2 v[94:95], v6, s[40:43], s57 offen offset:3072 sc1
    s_mov_b32 s44, s4
    s_mov_b32 s45, s5
    s_mov_b32 s46, 2560
    s_mov_b32 s47, 0x20000
    s_mov_b32 s36, s10
    s_mov_b32 s37, s11
    s_mov_b32 s38, 5242880
    s_mov_b32 s39, 0x20000
    buffer_load_dwordx2 v[44:45], v5, s[44:47], 0 offen offset:0
    buffer_load_dwordx2 v[46:47], v5, s[44:47], 0 offen offset:8
    buffer_load_dwordx2 v[48:49], v5, s[44:47], 0 offen offset:16
    buffer_load_dwordx2 v[50:51], v5, s[44:47], 0 offen offset:24
    buffer_load_dwordx2 v[52:53], v5, s[44:47], 0 offen offset:32
    buffer_load_dwordx4 v[96:99], v4, s[36:39], s48 offen nt
    s_add_u32 s48, s48, s49
    buffer_load_dwordx4 v[100:103], v4, s[36:39], s48 offen nt
    s_add_u32 s48, s48, s49
    buffer_load_dwordx4 v[104:107], v4, s[36:39], s48 offen nt
    s_add_u32 s48, s48, s49
    buffer_load_dwordx4 v[108:111], v4, s[36:39], s48 offen nt
    s_add_u32 s48, s48, s49
    buffer_load_dwordx4 v[112:115], v4, s[36:39], s48 offen nt
    s_add_u32 s48, s48, s49
    buffer_load_dwordx4 v[116:119], v4, s[36:39], s48 offen nt
    s_add_u32 s48, s48, s49
    buffer_load_dwordx4 v[120:123], v4, s[36:39], s48 offen nt
    s_add_u32 s48, s48, s49
    buffer_load_dwordx4 v[124:127], v4, s[36:39], s48 offen nt
    s_add_u32 s48, s48, s49
    buffer_load_dwordx4 v[128:131], v4, s[36:39], s48 offen nt
    s_add_u32 s48, s48, s49
    buffer_load_dwordx4 v[132:135], v4, s[36:39], s48 offen nt
    s_add_u32 s48, s48, s49
    buffer_load_dwordx4 v[136:139], v4, s[36:39], s48 offen nt
    s_add_u32 s48, s48, s49
    buffer_load_dwordx4 v[140:143], v4, s[36:39], s48 offen nt
    s_add_u32 s48, s48, s49
    buffer_load_dwordx4 v[144:147], v4, s[36:39], s48 offen nt
    s_add_u32 s48, s48, s49
    buffer_load_dwordx4 v[148:151], v4, s[36:39], s48 offen nt
    s_add_u32 s48, s48, s49
    buffer_load_dwordx4 v[152:155], v4, s[36:39], s48 offen nt
    s_add_u32 s48, s48, s49
    buffer_load_dwordx4 v[156:159], v4, s[36:39], s48 offen nt
    s_add_u32 s48, s48, s49
    buffer_load_dwordx4 v[160:163], v4, s[36:39], s48 offen nt
    s_add_u32 s48, s48, s49
    buffer_load_dwordx4 v[164:167], v4, s[36:39], s48 offen nt
    s_add_u32 s48, s48, s49
    buffer_load_dwordx4 v[168:171], v4, s[36:39], s48 offen nt
    s_add_u32 s48, s48, s49
    buffer_load_dwordx4 v[172:175], v4, s[36:39], s48 offen nt
    v_and_b32 v70, 1, v3
    v_mov_b32 v71, 0x0c0c0100
    v_mov_b32 v72, 0x01000c0c
    v_mov_b32 v73, 0x0c0c0302
    v_mov_b32 v74, 0x03020c0c
    v_cmp_eq_u32 vcc, 1, v70
    s_nop 1
    v_cndmask_b32 v71, v71, v72, vcc
    v_cndmask_b32 v73, v73, v74, vcc
    v_mov_b32 v75, 0x0c0c0c0c
    v_bfe_u32 v70, v3, 1, 2
    v_cmp_eq_u32 vcc, 0, v70
    s_nop 1
    v_cndmask_b32 v8, v75, v71, vcc
    v_cndmask_b32 v12, v75, v73, vcc
    v_cmp_eq_u32 vcc, 1, v70
    s_nop 1
    v_cndmask_b32 v9, v75, v71, vcc
    v_cndmask_b32 v13, v75, v73, vcc
    v_cmp_eq_u32 vcc, 2, v70
    s_nop 1
    v_cndmask_b32 v10, v75, v71, vcc
    v_cndmask_b32 v14, v75, v73, vcc
    v_cmp_eq_u32 vcc, 3, v70
    s_nop 1
    v_cndmask_b32 v11, v75, v71, vcc
    v_cndmask_b32 v15, v75, v73, vcc
    s_mov_b32 s64, s26
    s_mov_b32 s65, s27
    s_mov_b32 s66, 256
    s_mov_b32 s67, 0x20000
    s_mul_i32 s59, s30, 8
    v_mov_b32 v54, s59
    s_mov_b32 s69, 0x10001
    s_waitcnt vmcnt(20)
    v_perm_b32 v16, v44, v44, v8
    v_perm_b32 v17, v44, v44, v9
    v_perm_b32 v18, v44, v44, v10
    v_perm_b32 v19, v44, v44, v11
    s_waitcnt vmcnt(19)
    s_nop 0
    v_mfma_f32_16x16x32_bf16 v[24:27], v[16:19], v[96:99], 0
    v_perm_b32 v20, v44, v44, v12
    v_perm_b32 v21, v44, v44, v13
    v_perm_b32 v22, v44, v44, v14
    v_perm_b32 v23, v44, v44, v15
    s_waitcnt vmcnt(18)
    s_nop 0
    v_mfma_f32_16x16x32_bf16 v[24:27], v[20:23], v[100:103], v[24:27]
    v_perm_b32 v16, v45, v45, v8
    v_perm_b32 v17, v45, v45, v9
    v_perm_b32 v18, v45, v45, v10
    v_perm_b32 v19, v45, v45, v11
    s_waitcnt vmcnt(17)
    s_nop 0
    v_mfma_f32_16x16x32_bf16 v[24:27], v[16:19], v[104:107], v[24:27]
    v_perm_b32 v20, v45, v45, v12
    v_perm_b32 v21, v45, v45, v13
    v_perm_b32 v22, v45, v45, v14
    v_perm_b32 v23, v45, v45, v15
    s_waitcnt vmcnt(16)
    s_nop 0
    v_mfma_f32_16x16x32_bf16 v[24:27], v[20:23], v[108:111], v[24:27]
    v_perm_b32 v16, v46, v46, v8
    v_perm_b32 v17, v46, v46, v9
    v_perm_b32 v18, v46, v46, v10
    v_perm_b32 v19, v46, v46, v11
    s_waitcnt vmcnt(15)
    s_nop 0
    v_mfma_f32_16x16x32_bf16 v[24:27], v[16:19], v[112:115], v[24:27]
    v_perm_b32 v20, v46, v46, v12
    v_perm_b32 v21, v46, v46, v13
    v_perm_b32 v22, v46, v46, v14
    v_perm_b32 v23, v46, v46, v15
    s_waitcnt vmcnt(14)
    s_nop 0
    v_mfma_f32_16x16x32_bf16 v[24:27], v[20:23], v[116:119], v[24:27]
    v_perm_b32 v16, v47, v47, v8
    v_perm_b32 v17, v47, v47, v9
    v_perm_b32 v18, v47, v47, v10
    v_perm_b32 v19, v47, v47, v11
    s_waitcnt vmcnt(13)
    s_nop 0
    v_mfma_f32_16x16x32_bf16 v[24:27], v[16:19], v[120:123], v[24:27]
    v_perm_b32 v20, v47, v47, v12
    v_perm_b32 v21, v47, v47, v13
    v_perm_b32 v22, v47, v47, v14
    v_perm_b32 v23, v47, v47, v15
    s_waitcnt vmcnt(12)
    s_nop 0
    v_mfma_f32_16x16x32_bf16 v[24:27], v[20:23], v[124:127], v[24:27]
    v_perm_b32 v16, v48, v48, v8
    v_perm_b32 v17, v48, v48, v9
    v_perm_b32 v18, v48, v48, v10
    v_perm_b32 v19, v48, v48, v11
    s_waitcnt vmcnt(11)
    s_nop 0
    v_mfma_f32_16x16x32_bf16 v[24:27], v[16:19], v[128:131], v[24:27]
    v_perm_b32 v20, v48, v48, v12
    v_perm_b32 v21, v48, v48, v13
    v_perm_b32 v22, v48, v48, v14
    v_perm_b32 v23, v48, v48, v15
    s_waitcnt vmcnt(10)
    s_nop 0
    v_mfma_f32_16x16x32_bf16 v[24:27], v[20:23], v[132:135], v[24:27]
    v_perm_b32 v16, v49, v49, v8
    v_perm_b32 v17, v49, v49, v9
    v_perm_b32 v18, v49, v49, v10
    v_perm_b32 v19, v49, v49, v11
    s_waitcnt vmcnt(9)
    s_nop 0
    v_mfma_f32_16x16x32_bf16 v[24:27], v[16:19], v[136:139], v[24:27]
    v_perm_b32 v20, v49, v49, v12
    v_perm_b32 v21, v49, v49, v13
    v_perm_b32 v22, v49, v49, v14
    v_perm_b32 v23, v49, v49, v15
    s_waitcnt vmcnt(8)
    s_nop 0
    v_mfma_f32_16x16x32_bf16 v[24:27], v[20:23], v[140:143], v[24:27]
    v_perm_b32 v16, v50, v50, v8
    v_perm_b32 v17, v50, v50, v9
    v_perm_b32 v18, v50, v50, v10
    v_perm_b32 v19, v50, v50, v11
    s_waitcnt vmcnt(7)
    s_nop 0
    v_mfma_f32_16x16x32_bf16 v[24:27], v[16:19], v[144:147], v[24:27]
    v_perm_b32 v20, v50, v50, v12
    v_perm_b32 v21, v50, v50, v13
    v_perm_b32 v22, v50, v50, v14
    v_perm_b32 v23, v50, v50, v15
    s_waitcnt vmcnt(6)
    s_nop 0
    v_mfma_f32_16x16x32_bf16 v[24:27], v[20:23], v[148:151], v[24:27]
    v_perm_b32 v16, v51, v51, v8
    v_perm_b32 v17, v51, v51, v9
    v_perm_b32 v18, v51, v51, v10
    v_perm_b32 v19, v51, v51, v11
    s_waitcnt vmcnt(5)
    s_nop 0
    v_mfma_f32_16x16x32_bf16 v[24:27], v[16:19], v[152:155], v[24:27]
    v_perm_b32 v20, v51, v51, v12
    v_perm_b32 v21, v51, v51, v13
    v_perm_b32 v22, v51, v51, v14
    v_perm_b32 v23, v51, v51, v15
    s_waitcnt vmcnt(4)
    s_nop 0
    v_mfma_f32_16x16x32_bf16 v[24:27], v[20:23], v[156:159], v[24:27]
    v_perm_b32 v16, v52, v52, v8
    v_perm_b32 v17, v52, v52, v9
    v_perm_b32 v18, v52, v52, v10
    v_perm_b32 v19, v52, v52, v11
    s_waitcnt vmcnt(3)
    s_nop 0
    v_mfma_f32_16x16x32_bf16 v[24:27], v[16:19], v[160:163], v[24:27]
    v_perm_b32 v20, v52, v52, v12
    v_perm_b32 v21, v52, v52, v13
    v_perm_b32 v22, v52, v52, v14
    v_perm_b32 v23, v52, v52, v15
    s_waitcnt vmcnt(2)
    s_nop 0
    v_mfma_f32_16x16x32_bf16 v[24:27], v[20:23], v[164:167], v[24:27]
    v_perm_b32 v16, v53, v53, v8
    v_perm_b32 v17, v53, v53, v9
    v_perm_b32 v18, v53, v53, v10
    v_perm_b32 v19, v53, v53, v11
    s_waitcnt vmcnt(1)
    s_nop 0
    v_mfma_f32_16x16x32_bf16 v[24:27], v[16:19], v[168:171], v[24:27]
    v_perm_b32 v20, v53, v53, v12
    v_perm_b32 v21, v53, v53, v13
    v_perm_b32 v22, v53, v53, v14
    v_perm_b32 v23, v53, v53, v15
    s_waitcnt vmcnt(0)
    s_nop 0
    v_mfma_f32_16x16x32_bf16 v[24:27], v[20:23], v[172:175], v[24:27]
    v_lshlrev_b32 v5, 2, v1
    v_not_b32 v28, v28
    v_not_b32 v29, v29
    v_not_b32 v30, v30
    v_not_b32 v31, v31
    s_nop 2
    v_bfi_b32 v24, 1, v28, v24
    v_bfi_b32 v25, 1, v29, v25
    v_bfi_b32 v26, 1, v30, v26
    v_bfi_b32 v27, 1, v31, v27
    buffer_store_dwordx4 v[24:27], v7, s[40:43], s58 offen sc1
    s_mov_b32 s49, 0
L_a_qp:
    buffer_load_dwordx2 v[64:65], v6, s[40:43], s56 offen offset:0 sc1
    buffer_load_dwordx2 v[66:67], v6, s[40:43], s56 offen offset:1024 sc1
    buffer_load_dwordx2 v[68:69], v6, s[40:43], s56 offen offset:2048 sc1
    buffer_load_dwordx2 v[70:71], v6, s[40:43], s56 offen offset:3072 sc1
    buffer_load_dwordx2 v[72:73], v6, s[40:43], s57 offen offset:0 sc1
    buffer_load_dwordx2 v[74:75], v6, s[40:43], s57 offen offset:1024 sc1
    buffer_load_dwordx2 v[76:77], v6, s[40:43], s57 offen offset:2048 sc1
    buffer_load_dwordx2 v[78:79], v6, s[40:43], s57 offen offset:3072 sc1
    s_add_u32 s49, s49, 1
    s_waitcnt vmcnt(0)
    v_xor_b32 v28, v64, v80
    v_xor_b32 v29, v65, v81
    v_and_b32 v28, v28, v29
    v_xor_b32 v29, v66, v82
    v_and_b32 v28, v28, v29
    v_xor_b32 v29, v67, v83
    v_and_b32 v28, v28, v29
    v_xor_b32 v29, v68, v84
    v_and_b32 v28, v28, v29
    v_xor_b32 v29, v69, v85
    v_and_b32 v28, v28, v29
    v_xor_b32 v29, v70, v86
    v_and_b32 v28, v28, v29
    v_xor_b32 v29, v71, v87
    v_and_b32 v28, v28, v29
    v_xor_b32 v29, v72, v88
    v_and_b32 v28, v28, v29
    v_xor_b32 v29, v73, v89
    v_and_b32 v28, v28, v29
    v_xor_b32 v29, v74, v90
    v_and_b32 v28, v28, v29
    v_xor_b32 v29, v75, v91
    v_and_b32 v28, v28, v29
    v_xor_b32 v29, v76, v92
    v_and_b32 v28, v28, v29
    v_xor_b32 v29, v77, v93
    v_and_b32 v28, v28, v29
    v_xor_b32 v29, v78, v94
    v_and_b32 v28, v28, v29
    v_xor_b32 v29, v79, v95
    v_and_b32 v28, v28, v29
    v_and_b32 v28, 1, v28
    v_cmp_eq_u32 vcc, 0, v28
    s_cmp_ge_u32 s49, 65536
    s_cbranch_scc1 L_a_q_got
    s_cbranch_vccz L_a_q_got
    s_cmp_lt_u32 s49, 6
    s_cbranch_scc1 L_a_qp
    s_cmp_eq_u32 s49, 6
    s_cbranch_scc0 L_a_q_noset
    v_mov_b32 v28, 0x7fff0000
    v_cmp_eq_u32 vcc, 0, v1
    s_nop 1
    v_cndmask_b32 v28, v28, v54, vcc
    v_mov_b32 v29, 1
    buffer_atomic_add v29, v28, s[64:67], 0 offen sc1
    s_mov_b32 s69, 0x10000
L_a_q_noset:
    buffer_load_dword v28, v54, s[64:67], 0 offen sc1
    s_waitcnt vmcnt(0)
    v_and_b32 v28, 0xffff, v28
    s_nop 0
    v_readfirstlane_b32 s55, v28
    s_cmp_ge_u32 s55, 8
    s_cbranch_scc1 L_a_q_flagged
    s_sleep 8
    s_branch L_a_qp
L_a_q_flagged:
    buffer_load_dwordx2 v[64:65], v6, s[40:43], s56 offen offset:0 sc1
    buffer_load_dwordx2 v[66:67], v6, s[40:43], s56 offen offset:1024 sc1
    buffer_load_dwordx2 v[68:69], v6, s[40:43], s56 offen offset:2048 sc1
    buffer_load_dwordx2 v[70:71], v6, s[40:43], s56 offen offset:3072 sc1
    buffer_load_dwordx2 v[72:73], v6, s[40:43], s57 offen offset:0 sc1
    buffer_load_dwordx2 v[74:75], v6, s[40:43], s57 offen offset:1024 sc1
    buffer_load_dwordx2 v[76:77], v6, s[40:43], s57 offen offset:2048 sc1
    buffer_load_dwordx2 v[78:79], v6, s[40:43], s57 offen offset:3072 sc1
    s_waitcnt vmcnt(0)
L_a_q_got:
    v_and_b32 v64, -2, v64
    v_and_b32 v65, -2, v65
    v_and_b32 v66, -2, v66
    v_and_b32 v67, -2, v67
    v_and_b32 v68, -2, v68
    v_and_b32 v69, -2, v69
    v_and_b32 v70, -2, v70
    v_and_b32 v71, -2, v71
    v_and_b32 v72, -2, v72
    v_and_b32 v73, -2, v73
    v_and_b32 v74, -2, v74
    v_and_b32 v75, -2, v75
    v_and_b32 v76, -2, v76
    v_and_b32 v77, -2, v77
    v_and_b32 v78, -2, v78
    v_and_b32 v79, -2, v79
    v_add_f32 v64, v64, v66
    v_add_f32 v68, v68, v70
    v_add_f32 v72, v72, v74
    v_add_f32 v76, v76, v78
    v_add_f32 v64, v64, v68
    v_add_f32 v72, v72, v76
    v_add_f32 v64, v64, v72
    v_add_f32 v65, v65, v67
    v_add_f32 v69, v69, v71
    v_add_f32 v73, v73, v75
    v_add_f32 v77, v77, v79
    v_add_f32 v65, v65, v69
    v_add_f32 v73, v73, v77
    v_add_f32 v65, v65, v73
    v_cvt_pk_bf16_f32 v64, v64, v65
    ds_write_b32 v5, v64 offset:0
    s_waitcnt lgkmcnt(0)
    s_branch L_a_barA
L_a_notw0:
    s_waitcnt lgkmcnt(0)
    s_mov_b32 s44, s4
    s_mov_b32 s45, s5
    s_mov_b32 s46, 2560
    s_mov_b32 s47, 0x20000
    s_mov_b32 s40, s28
    s_mov_b32 s41, s29
    s_mov_b32 s42, 0x1ba000
    s_mov_b32 s43, 0x20000
    s_mov_b32 s64, s26
    s_mov_b32 s65, s27
    s_mov_b32 s66, 256
    s_mov_b32 s67, 0x20000
    s_and_b32 s54, s2, 7
    s_lshr_b32 s55, s2, 3
    s_lshr_b32 s56, s54, 1
    s_mul_i32 s57, s56, 24
    s_add_u32 s57, s57, 128
    s_add_u32 s57, s57, s55
    s_cmp_ge_u32 s55, 24
    s_cselect_b32 s57, 999, s57
    s_lshl_b32 s35, s56, 5
    s_add_u32 s35, s35, s55
    s_bitcmp1_b32 s54, 0
    s_cselect_b32 s35, s57, s35
    s_lshl_b32 s57, s32, 2
    s_and_b32 s59, s55, 3
    s_add_u32 s57, s57, s59
    s_mul_i32 s59, s56, 11
    s_add_u32 s59, s59, s57
    s_add_u32 s59, s59, 59
    s_cmp_lt_u32 s57, 5
    s_cselect_b32 s59, 999, s59
    s_lshl_b32 s61, s56, 4
    s_add_u32 s61, s61, s57
    s_bitcmp1_b32 s54, 0
    s_cselect_b32 s61, s59, s61
    s_cmp_eq_u32 s3, 2
    s_cbranch_scc0 L_a_noclear
    v_mov_b32 v64, 0xffffffff
    v_mov_b32 v65, v64
    v_mov_b32 v66, v64
    v_mov_b32 v67, v64
    v_lshlrev_b32 v68, 4, v1
    s_mul_i32 s56, s34, 2560
    v_mov_b32 v70, 0x7fff0000
    v_cmp_gt_u32 vcc, 32, v1
    s_nop 1
    v_cndmask_b32 v69, v70, v68, vcc
    buffer_store_dwordx4 v[64:67], v68, s[40:43], s56 offen sc1
    buffer_store_dwordx4 v[64:67], v68, s[40:43], s56 offen offset:1024 sc1
    buffer_store_dwordx4 v[64:67], v69, s[40:43], s56 offen offset:2048 sc1
    s_lshl_b32 s56, s34, 9
    s_add_u32 s56, s56, 1679360
    v_cmp_gt_u32 vcc, 32, v1
    s_nop 1
    v_cndmask_b32 v69, v70, v68, vcc
    buffer_store_dwordx4 v[64:67], v69, s[40:43], s56 offen sc1
    s_cmp_lt_u32 s35, 224
    s_cbranch_scc0 L_a_noclear_f
    s_lshl_b32 s56, s35, 10
    s_add_u32 s56, s56, 925696
    buffer_store_dwordx4 v[64:67], v68, s[40:43], s56 offen sc1
L_a_noclear_f:
    s_waitcnt vmcnt(0)
L_a_noclear:
    s_cmp_eq_u32 s3, 3
    s_cbranch_scc0 L_a_nogate
    s_mov_b32 s36, s22
    s_mov_b32 s37, s23
    s_mov_b32 s38, 1280
    s_mov_b32 s39, 0x20000
    v_lshlrev_b32 v72, 5, v1
    v_mov_b32 v73, 0x7fff0000
    v_cmp_gt_u32 vcc, 40, v1
    s_nop 1
    v_cndmask_b32 v72, v73, v72, vcc
    buffer_load_dwordx4 v[44:47], v72, s[44:47], 0 offen
    buffer_load_dwordx4 v[48:51], v72, s[44:47], 0 offen offset:16
    buffer_load_dwordx4 v[52:55], v72, s[44:47], 0 offen offset:1280
    buffer_load_dwordx4 v[56:59], v72, s[44:47], 0 offen offset:1296
    buffer_load_dwordx4 v[64:67], v72, s[36:39], 0 offen
    buffer_load_dwordx4 v[68:71], v72, s[36:39], 0 offen offset:16
    s_waitcnt vmcnt(0)
    v_mov_b32 v74, 0
    v_mov_b32 v75, 0
    v_lshlrev_b32 v76, 16, v44
    v_lshlrev_b32 v77, 16, v64
    v_and_b32 v78, 0xffff0000, v44
    v_and_b32 v79, 0xffff0000, v64
    v_mul_f32 v76, v76, v77
    v_mul_f32 v78, v78, v79
    v_cvt_pk_bf16_f32 v76, v76, v78
    v_lshlrev_b32 v77, 16, v76
    v_and_b32 v76, 0xffff0000, v76
    v_add_f32 v74, v74, v77
    v_add_f32 v74, v74, v76
    v_lshlrev_b32 v76, 16, v45
    v_lshlrev_b32 v77, 16, v65
    v_and_b32 v78, 0xffff0000, v45
    v_and_b32 v79, 0xffff0000, v65
    v_mul_f32 v76, v76, v77
    v_mul_f32 v78, v78, v79
    v_cvt_pk_bf16_f32 v76, v76, v78
    v_lshlrev_b32 v77, 16, v76
    v_and_b32 v76, 0xffff0000, v76
    v_add_f32 v74, v74, v77
    v_add_f32 v74, v74, v76
    v_lshlrev_b32 v76, 16, v46
    v_lshlrev_b32 v77, 16, v66
    v_and_b32 v78, 0xffff0000, v46
    v_and_b32 v79, 0xffff0000, v66
    v_mul_f32 v76, v76, v77
    v_mul_f32 v78, v78, v79
    v_cvt_pk_bf16_f32 v76, v76, v78
    v_lshlrev_b32 v77, 16, v76
    v_and_b32 v76, 0xffff0000, v76
    v_add_f32 v74, v74, v77
    v_add_f32 v74, v74, v76
    v_lshlrev_b32 v76, 16, v47
    v_lshlrev_b32 v77, 16, v67
    v_and_b32 v78, 0xffff0000, v47
    v_and_b32 v79, 0xffff0000, v67
    v_mul_f32 v76, v76, v77
    v_mul_f32 v78, v78, v79
    v_cvt_pk_bf16_f32 v76, v76, v78
    v_lshlrev_b32 v77, 16, v76
    v_and_b32 v76, 0xffff0000, v76
    v_add_f32 v74, v74, v77
    v_add_f32 v74, v74, v76
    v_lshlrev_b32 v76, 16, v48
    v_lshlrev_b32 v77, 16, v68
    v_and_b32 v78, 0xffff0000, v48
    v_and_b32 v79, 0xffff0000, v68
    v_mul_f32 v76, v76, v77
    v_mul_f32 v78, v78, v79
    v_cvt_pk_bf16_f32 v76, v76, v78
    v_lshlrev_b32 v77, 16, v76
    v_and_b32 v76, 0xffff0000, v76
    v_add_f32 v74, v74, v77
    v_add_f32 v74, v74, v76
    v_lshlrev_b32 v76, 16, v49
    v_lshlrev_b32 v77, 16, v69
    v_and_b32 v78, 0xffff0000, v49
    v_and_b32 v79, 0xffff0000, v69
    v_mul_f32 v76, v76, v77
    v_mul_f32 v78, v78, v79
    v_cvt_pk_bf16_f32 v76, v76, v78
    v_lshlrev_b32 v77, 16, v76
    v_and_b32 v76, 0xffff0000, v76
    v_add_f32 v74, v74, v77
    v_add_f32 v74, v74, v76
    v_lshlrev_b32 v76, 16, v50
    v_lshlrev_b32 v77, 16, v70
    v_and_b32 v78, 0xffff0000, v50
    v_and_b32 v79, 0xffff0000, v70
    v_mul_f32 v76, v76, v77
    v_mul_f32 v78, v78, v79
    v_cvt_pk_bf16_f32 v76, v76, v78
    v_lshlrev_b32 v77, 16, v76
    v_and_b32 v76, 0xffff0000, v76
    v_add_f32 v74, v74, v77
    v_add_f32 v74, v74, v76
    v_lshlrev_b32 v76, 16, v51
    v_lshlrev_b32 v77, 16, v71
    v_and_b32 v78, 0xffff0000, v51
    v_and_b32 v79, 0xffff0000, v71
    v_mul_f32 v76, v76, v77
    v_mul_f32 v78, v78, v79
    v_cvt_pk_bf16_f32 v76, v76, v78
    v_lshlrev_b32 v77, 16, v76
    v_and_b32 v76, 0xffff0000, v76
    v_add_f32 v74, v74, v77
    v_add_f32 v74, v74, v76
    v_lshlrev_b32 v76, 16, v52
    v_lshlrev_b32 v77, 16, v64
    v_and_b32 v78, 0xffff0000, v52
    v_and_b32 v79, 0xffff0000, v64
    v_mul_f32 v76, v76, v77
    v_mul_f32 v78, v78, v79
    v_cvt_pk_bf16_f32 v76, v76, v78
    v_lshlrev_b32 v77, 16, v76
    v_and_b32 v76, 0xffff0000, v76
    v_add_f32 v75, v75, v77
    v_add_f32 v75, v75, v76
    v_lshlrev_b32 v76, 16, v53
    v_lshlrev_b32 v77, 16, v65
    v_and_b32 v78, 0xffff0000, v53
    v_and_b32 v79, 0xffff0000, v65
    v_mul_f32 v76, v76, v77
    v_mul_f32 v78, v78, v79
    v_cvt_pk_bf16_f32 v76, v76, v78
    v_lshlrev_b32 v77, 16, v76
    v_and_b32 v76, 0xffff0000, v76
    v_add_f32 v75, v75, v77
    v_add_f32 v75, v75, v76
    v_lshlrev_b32 v76, 16, v54
    v_lshlrev_b32 v77, 16, v66
    v_and_b32 v78, 0xffff0000, v54
    v_and_b32 v79, 0xffff0000, v66
    v_mul_f32 v76, v76, v77
    v_mul_f32 v78, v78, v79
    v_cvt_pk_bf16_f32 v76, v76, v78
    v_lshlrev_b32 v77, 16, v76
    v_and_b32 v76, 0xffff0000, v76
    v_add_f32 v75, v75, v77
    v_add_f32 v75, v75, v76
    v_lshlrev_b32 v76, 16, v55
    v_lshlrev_b32 v77, 16, v67
    v_and_b32 v78, 0xffff0000, v55
    v_and_b32 v79, 0xffff0000, v67
    v_mul_f32 v76, v76, v77
    v_mul_f32 v78, v78, v79
    v_cvt_pk_bf16_f32 v76, v76, v78
    v_lshlrev_b32 v77, 16, v76
    v_and_b32 v76, 0xffff0000, v76
    v_add_f32 v75, v75, v77
    v_add_f32 v75, v75, v76
    v_lshlrev_b32 v76, 16, v56
    v_lshlrev_b32 v77, 16, v68
    v_and_b32 v78, 0xffff0000, v56
    v_and_b32 v79, 0xffff0000, v68
    v_mul_f32 v76, v76, v77
    v_mul_f32 v78, v78, v79
    v_cvt_pk_bf16_f32 v76, v76, v78
    v_lshlrev_b32 v77, 16, v76
    v_and_b32 v76, 0xffff0000, v76
    v_add_f32 v75, v75, v77
    v_add_f32 v75, v75, v76
    v_lshlrev_b32 v76, 16, v57
    v_lshlrev_b32 v77, 16, v69
    v_and_b32 v78, 0xffff0000, v57
    v_and_b32 v79, 0xffff0000, v69
    v_mul_f32 v76, v76, v77
    v_mul_f32 v78, v78, v79
    v_cvt_pk_bf16_f32 v76, v76, v78
    v_lshlrev_b32 v77, 16, v76
    v_and_b32 v76, 0xffff0000, v76
    v_add_f32 v75, v75, v77
    v_add_f32 v75, v75, v76
    v_lshlrev_b32 v76, 16, v58
    v_lshlrev_b32 v77, 16, v70
    v_and_b32 v78, 0xffff0000, v58
    v_and_b32 v79, 0xffff0000, v70
    v_mul_f32 v76, v76, v77
    v_mul_f32 v78, v78, v79
    v_cvt_pk_bf16_f32 v76, v76, v78
    v_lshlrev_b32 v77, 16, v76
    v_and_b32 v76, 0xffff0000, v76
    v_add_f32 v75, v75, v77
    v_add_f32 v75, v75, v76
    v_lshlrev_b32 v76, 16, v59
    v_lshlrev_b32 v77, 16, v71
    v_and_b32 v78, 0xffff0000, v59
    v_and_b32 v79, 0xffff0000, v71
    v_mul_f32 v76, v76, v77
    v_mul_f32 v78, v78, v79
    v_cvt_pk_bf16_f32 v76, v76, v78
    v_lshlrev_b32 v77, 16, v76
    v_and_b32 v76, 0xffff0000, v76
    v_add_f32 v75, v75, v77
    v_add_f32 v75, v75, v76
    v_add_f32_dpp v74, v74, v74 row_ror:8 row_mask:0xf bank_mask:0xf
    s_nop 1
    v_add_f32_dpp v74, v74, v74 row_ror:4 row_mask:0xf bank_mask:0xf
    s_nop 1
    v_add_f32_dpp v74, v74, v74 row_ror:2 row_mask:0xf bank_mask:0xf
    s_nop 1
    v_add_f32_dpp v74, v74, v74 row_ror:1 row_mask:0xf bank_mask:0xf
    s_nop 0
    v_readlane_b32 s54, v74, 0
    v_readlane_b32 s55, v74, 16
    v_readlane_b32 s56, v74, 32
    v_readlane_b32 s58, v74, 48
    v_mov_b32 v74, s54
    v_add_f32 v74, s55, v74
    v_add_f32 v74, s56, v74
    v_add_f32 v74, s58, v74
    v_add_f32_dpp v75, v75, v75 row_ror:8 row_mask:0xf bank_mask:0xf
    s_nop 1
    v_add_f32_dpp v75, v75, v75 row_ror:4 row_mask:0xf bank_mask:0xf
    s_nop 1
    v_add_f32_dpp v75, v75, v75 row_ror:2 row_mask:0xf bank_mask:0xf
    s_nop 1
    v_add_f32_dpp v75, v75, v75 row_ror:1 row_mask:0xf bank_mask:0xf
    s_nop 0
    v_readlane_b32 s54, v75, 0
    v_readlane_b32 s55, v75, 16
    v_readlane_b32 s56, v75, 32
    v_readlane_b32 s58, v75, 48
    v_mov_b32 v75, s54
    v_add_f32 v75, s55, v75
    v_add_f32 v75, s56, v75
    v_add_f32 v75, s58, v75
    v_cvt_pk_bf16_f32 v74, v74, v74
    v_lshlrev_b32 v74, 16, v74
    v_mul_f32 v74, 0xbfb8aa3b, v74
    v_exp_f32 v74, v74
    s_nop 0
    v_add_f32 v74, 1.0, v74
    v_rcp_f32 v74, v74
    s_nop 0
    v_cvt_pk_bf16_f32 v74, v74, v74
    v_lshlrev_b32 v74, 16, v74
    v_sub_f32 v76, 1.0, v74
    v_cvt_pk_bf16_f32 v76, v76, v76
    v_lshlrev_b32 v76, 16, v76
    v_cvt_pk_bf16_f32 v75, v75, v75
    v_lshlrev_b32 v75, 16, v75
    v_mul_f32 v75, 0xbfb8aa3b, v75
    v_exp_f32 v75, v75
    s_nop 0
    v_add_f32 v75, 1.0, v75
    v_rcp_f32 v75, v75
    s_nop 0
    v_cvt_pk_bf16_f32 v75, v75, v75
    v_lshlrev_b32 v75, 16, v75
    v_sub_f32 v77, 1.0, v75
    v_cvt_pk_bf16_f32 v77, v77, v77
    v_lshlrev_b32 v77, 16, v77
    v_mov_b32 v72, 0
    ds_write_b128 v72, v[74:77] offset:1024
    ds_write_b32 v72, v72 offset:1040
    s_waitcnt lgkmcnt(0)
L_a_nogate:
    v_and_b32 v70, 1, v3
    v_mov_b32 v71, 0x0c0c0100
    v_mov_b32 v72, 0x01000c0c
    v_mov_b32 v73, 0x0c0c0302
    v_mov_b32 v74, 0x03020c0c
    v_cmp_eq_u32 vcc, 1, v70
    s_nop 1
    v_cndmask_b32 v71, v71, v72, vcc
    v_cndmask_b32 v73, v73, v74, vcc
    v_mov_b32 v75, 0x0c0c0c0c
    v_bfe_u32 v70, v3, 1, 2
    v_cmp_eq_u32 vcc, 0, v70
    s_nop 1
    v_cndmask_b32 v8, v75, v71, vcc
    v_cndmask_b32 v12, v75, v73, vcc
    v_cmp_eq_u32 vcc, 1, v70
    s_nop 1
    v_cndmask_b32 v9, v75, v71, vcc
    v_cndmask_b32 v13, v75, v73, vcc
    v_cmp_eq_u32 vcc, 2, v70
    s_nop 1
    v_cndmask_b32 v10, v75, v71, vcc
    v_cndmask_b32 v14, v75, v73, vcc
    v_cmp_eq_u32 vcc, 3, v70
    s_nop 1
    v_cndmask_b32 v11, v75, v71, vcc
    v_cndmask_b32 v15, v75, v73, vcc
L_a_barA:
    s_barrier
    s_cmp_eq_u32 s3, 0
    s_cbranch_scc0 L_a_notw0b
    v_mov_b32 v68, 0x7fff0000
    v_cmp_eq_u32 vcc, 0, v1
    s_nop 1
    v_cndmask_b32 v68, v68, v54, vcc
    v_mov_b32 v69, s69
    buffer_atomic_add v69, v68, s[64:67], 0 offen sc1
    s_and_b32 s54, s2, 7
    s_lshr_b32 s55, s2, 3
    s_lshr_b32 s56, s54, 1
    s_mul_i32 s57, s56, 24
    s_add_u32 s57, s57, 128
    s_add_u32 s57, s57, s55
    s_cmp_ge_u32 s55, 24
    s_cselect_b32 s57, 999, s57
    s_lshl_b32 s35, s56, 5
    s_add_u32 s35, s35, s55
    s_bitcmp1_b32 s54, 0
    s_cselect_b32 s35, s57, s35
    s_lshl_b32 s57, s32, 2
    s_and_b32 s59, s55, 3
    s_add_u32 s57, s57, s59
    s_mul_i32 s59, s56, 11
    s_add_u32 s59, s59, s57
    s_add_u32 s59, s59, 59
    s_cmp_lt_u32 s57, 5
    s_cselect_b32 s59, 999, s59
    s_lshl_b32 s61, s56, 4
    s_add_u32 s61, s61, s57
    s_bitcmp1_b32 s54, 0
    s_cselect_b32 s61, s59, s61
L_a_notw0b:
    s_cmp_eq_u32 s3, 1
    s_cbranch_scc0 L_a_notw1
    s_cmp_lt_u32 s35, 224
    s_cbranch_scc0 L_a_notw1
    s_and_b32 s57, s35, 7
    s_mul_i32 s57, s57, 80
    v_mad_u32_u24 v64, v2, 20, s57
    v_lshrrev_b32 v6, 3, v3
    v_mul_u32_u24 v6, 1280, v6
    v_lshl_add_u32 v65, v64, 1, v6
    v_mul_u32_u24 v64, 3456, v64
    s_lshr_b32 s57, s35, 3
    s_cmp_ge_u32 s57, 14
    s_cselect_b32 s36, s18, s16
    s_cselect_b32 s37, s19, s17
    s_cselect_b32 s56, 14, 0
    s_sub_u32 s57, s57, s56
    s_lshl_b32 s57, s57, 8
    s_mov_b32 s38, 2211840
    s_mov_b32 s39, 0x20000
    v_lshl_add_u32 v66, v3, 4, s57
    v_add_u32 v64, v64, v66
    s_mov_b32 s48, 0
    s_movk_i32 s49, 3456
    buffer_load_dwordx2 v[44:45], v65, s[44:47], 0 offen offset:0
    buffer_load_dwordx2 v[46:47], v65, s[44:47], 0 offen offset:8
    buffer_load_dwordx2 v[48:49], v65, s[44:47], 0 offen offset:16
    buffer_load_dwordx2 v[50:51], v65, s[44:47], 0 offen offset:24
    buffer_load_dwordx2 v[52:53], v65, s[44:47], 0 offen offset:32
    buffer_load_dwordx4 v[96:99], v64, s[36:39], s48 offen nt
    s_add_u32 s48, s48, s49
    buffer_load_dwordx4 v[100:103], v64, s[36:39], s48 offen nt
    s_add_u32 s48, s48, s49
    buffer_load_dwordx4 v[104:107], v64, s[36:39], s48 offen nt
    s_add_u32 s48, s48, s49
    buffer_load_dwordx4 v[108:111], v64, s[36:39], s48 offen nt
    s_add_u32 s48, s48, s49
    buffer_load_dwordx4 v[112:115], v64, s[36:39], s48 offen nt
    s_add_u32 s48, s48, s49
    buffer_load_dwordx4 v[116:119], v64, s[36:39], s48 offen nt
    s_add_u32 s48, s48, s49
    buffer_load_dwordx4 v[120:123], v64, s[36:39], s48 offen nt
    s_add_u32 s48, s48, s49
    buffer_load_dwordx4 v[124:127], v64, s[36:39], s48 offen nt
    s_add_u32 s48, s48, s49
    buffer_load_dwordx4 v[128:131], v64, s[36:39], s48 offen nt
    s_add_u32 s48, s48, s49
    buffer_load_dwordx4 v[132:135], v64, s[36:39], s48 offen nt
    s_add_u32 s48, s48, s49
    buffer_load_dwordx4 v[136:139], v64, s[36:39], s48 offen nt
    s_add_u32 s48, s48, s49
    buffer_load_dwordx4 v[140:143], v64, s[36:39], s48 offen nt
    s_add_u32 s48, s48, s49
    buffer_load_dwordx4 v[144:147], v64, s[36:39], s48 offen nt
    s_add_u32 s48, s48, s49
    buffer_load_dwordx4 v[148:151], v64, s[36:39], s48 offen nt
    s_add_u32 s48, s48, s49
    buffer_load_dwordx4 v[152:155], v64, s[36:39], s48 offen nt
    s_add_u32 s48, s48, s49
    buffer_load_dwordx4 v[156:159], v64, s[36:39], s48 offen nt
    s_add_u32 s48, s48, s49
    buffer_load_dwordx4 v[160:163], v64, s[36:39], s48 offen nt
    s_add_u32 s48, s48, s49
    buffer_load_dwordx4 v[164:167], v64, s[36:39], s48 offen nt
    s_add_u32 s48, s48, s49
    buffer_load_dwordx4 v[168:171], v64, s[36:39], s48 offen nt
    s_add_u32 s48, s48, s49
    buffer_load_dwordx4 v[172:175], v64, s[36:39], s48 offen nt
    v_lshrrev_b32 v7, 1, v2
    v_lshlrev_b32 v7, 9, v7
    v_and_b32 v5, 1, v2
    v_lshl_add_u32 v7, v5, 4, v7
    v_lshl_add_u32 v7, v3, 5, v7
    s_lshl_b32 s57, s35, 10
    s_add_u32 s57, s57, 925696
    s_waitcnt vmcnt(20)
    v_perm_b32 v16, v44, v44, v8
    v_perm_b32 v17, v44, v44, v9
    v_perm_b32 v18, v44, v44, v10
    v_perm_b32 v19, v44, v44, v11
    s_waitcnt vmcnt(19)
    s_nop 0
    v_mfma_f32_16x16x32_bf16 v[24:27], v[16:19], v[96:99], 0
    v_perm_b32 v20, v44, v44, v12
    v_perm_b32 v21, v44, v44, v13
    v_perm_b32 v22, v44, v44, v14
    v_perm_b32 v23, v44, v44, v15
    s_waitcnt vmcnt(18)
    s_nop 0
    v_mfma_f32_16x16x32_bf16 v[24:27], v[20:23], v[100:103], v[24:27]
    v_perm_b32 v16, v45, v45, v8
    v_perm_b32 v17, v45, v45, v9
    v_perm_b32 v18, v45, v45, v10
    v_perm_b32 v19, v45, v45, v11
    s_waitcnt vmcnt(17)
    s_nop 0
    v_mfma_f32_16x16x32_bf16 v[24:27], v[16:19], v[104:107], v[24:27]
    v_perm_b32 v20, v45, v45, v12
    v_perm_b32 v21, v45, v45, v13
    v_perm_b32 v22, v45, v45, v14
    v_perm_b32 v23, v45, v45, v15
    s_waitcnt vmcnt(16)
    s_nop 0
    v_mfma_f32_16x16x32_bf16 v[24:27], v[20:23], v[108:111], v[24:27]
    v_perm_b32 v16, v46, v46, v8
    v_perm_b32 v17, v46, v46, v9
    v_perm_b32 v18, v46, v46, v10
    v_perm_b32 v19, v46, v46, v11
    s_waitcnt vmcnt(15)
    s_nop 0
    v_mfma_f32_16x16x32_bf16 v[24:27], v[16:19], v[112:115], v[24:27]
    v_perm_b32 v20, v46, v46, v12
    v_perm_b32 v21, v46, v46, v13
    v_perm_b32 v22, v46, v46, v14
    v_perm_b32 v23, v46, v46, v15
    s_waitcnt vmcnt(14)
    s_nop 0
    v_mfma_f32_16x16x32_bf16 v[24:27], v[20:23], v[116:119], v[24:27]
    v_perm_b32 v16, v47, v47, v8
    v_perm_b32 v17, v47, v47, v9
    v_perm_b32 v18, v47, v47, v10
    v_perm_b32 v19, v47, v47, v11
    s_waitcnt vmcnt(13)
    s_nop 0
    v_mfma_f32_16x16x32_bf16 v[24:27], v[16:19], v[120:123], v[24:27]
    v_perm_b32 v20, v47, v47, v12
    v_perm_b32 v21, v47, v47, v13
    v_perm_b32 v22, v47, v47, v14
    v_perm_b32 v23, v47, v47, v15
    s_waitcnt vmcnt(12)
    s_nop 0
    v_mfma_f32_16x16x32_bf16 v[24:27], v[20:23], v[124:127], v[24:27]
    v_perm_b32 v16, v48, v48, v8
    v_perm_b32 v17, v48, v48, v9
    v_perm_b32 v18, v48, v48, v10
    v_perm_b32 v19, v48, v48, v11
    s_waitcnt vmcnt(11)
    s_nop 0
    v_mfma_f32_16x16x32_bf16 v[24:27], v[16:19], v[128:131], v[24:27]
    v_perm_b32 v20, v48, v48, v12
    v_perm_b32 v21, v48, v48, v13
    v_perm_b32 v22, v48, v48, v14
    v_perm_b32 v23, v48, v48, v15
    s_waitcnt vmcnt(10)
    s_nop 0
    v_mfma_f32_16x16x32_bf16 v[24:27], v[20:23], v[132:135], v[24:27]
    v_perm_b32 v16, v49, v49, v8
    v_perm_b32 v17, v49, v49, v9
    v_perm_b32 v18, v49, v49, v10
    v_perm_b32 v19, v49, v49, v11
    s_waitcnt vmcnt(9)
    s_nop 0
    v_mfma_f32_16x16x32_bf16 v[24:27], v[16:19], v[136:139], v[24:27]
    v_perm_b32 v20, v49, v49, v12
    v_perm_b32 v21, v49, v49, v13
    v_perm_b32 v22, v49, v49, v14
    v_perm_b32 v23, v49, v49, v15
    s_waitcnt vmcnt(8)
    s_nop 0
    v_mfma_f32_16x16x32_bf16 v[24:27], v[20:23], v[140:143], v[24:27]
    v_perm_b32 v16, v50, v50, v8
    v_perm_b32 v17, v50, v50, v9
    v_perm_b32 v18, v50, v50, v10
    v_perm_b32 v19, v50, v50, v11
    s_waitcnt vmcnt(7)
    s_nop 0
    v_mfma_f32_16x16x32_bf16 v[24:27], v[16:19], v[144:147], v[24:27]
    v_perm_b32 v20, v50, v50, v12
    v_perm_b32 v21, v50, v50, v13
    v_perm_b32 v22, v50, v50, v14
    v_perm_b32 v23, v50, v50, v15
    s_waitcnt vmcnt(6)
    s_nop 0
    v_mfma_f32_16x16x32_bf16 v[24:27], v[20:23], v[148:151], v[24:27]
    v_perm_b32 v16, v51, v51, v8
    v_perm_b32 v17, v51, v51, v9
    v_perm_b32 v18, v51, v51, v10
    v_perm_b32 v19, v51, v51, v11
    s_waitcnt vmcnt(5)
    s_nop 0
    v_mfma_f32_16x16x32_bf16 v[24:27], v[16:19], v[152:155], v[24:27]
    v_perm_b32 v20, v51, v51, v12
    v_perm_b32 v21, v51, v51, v13
    v_perm_b32 v22, v51, v51, v14
    v_perm_b32 v23, v51, v51, v15
    s_waitcnt vmcnt(4)
    s_nop 0
    v_mfma_f32_16x16x32_bf16 v[24:27], v[20:23], v[156:159], v[24:27]
    v_perm_b32 v16, v52, v52, v8
    v_perm_b32 v17, v52, v52, v9
    v_perm_b32 v18, v52, v52, v10
    v_perm_b32 v19, v52, v52, v11
    s_waitcnt vmcnt(3)
    s_nop 0
    v_mfma_f32_16x16x32_bf16 v[24:27], v[16:19], v[160:163], v[24:27]
    v_perm_b32 v20, v52, v52, v12
    v_perm_b32 v21, v52, v52, v13
    v_perm_b32 v22, v52, v52, v14
    v_perm_b32 v23, v52, v52, v15
    s_waitcnt vmcnt(2)
    s_nop 0
    v_mfma_f32_16x16x32_bf16 v[24:27], v[20:23], v[164:167], v[24:27]
    v_perm_b32 v16, v53, v53, v8
    v_perm_b32 v17, v53, v53, v9
    v_perm_b32 v18, v53, v53, v10
    v_perm_b32 v19, v53, v53, v11
    s_waitcnt vmcnt(1)
    s_nop 0
    v_mfma_f32_16x16x32_bf16 v[24:27], v[16:19], v[168:171], v[24:27]
    v_perm_b32 v20, v53, v53, v12
    v_perm_b32 v21, v53, v53, v13
    v_perm_b32 v22, v53, v53, v14
    v_perm_b32 v23, v53, v53, v15
    s_waitcnt vmcnt(0)
    s_nop 0
    v_mfma_f32_16x16x32_bf16 v[24:27], v[20:23], v[172:175], v[24:27]
    s_nop 7
    v_min_u32 v24, 0xfffffffe, v24
    v_min_u32 v25, 0xfffffffe, v25
    v_min_u32 v26, 0xfffffffe, v26
    v_min_u32 v27, 0xfffffffe, v27
    buffer_store_dwordx4 v[24:27], v7, s[40:43], s57 offen sc1
L_a_notw1:
    v_mov_b32 v72, 0
    ds_read_b128 v[64:67], v72 offset:1024
    s_waitcnt lgkmcnt(0)
    v_readfirstlane_b32 s62, v64
    v_readfirstlane_b32 s63, v65
    v_readfirstlane_b32 s50, v66
    v_readfirstlane_b32 s51, v67
    s_mov_b32 s36, s12
    s_mov_b32 s37, s13
    s_mov_b32 s38, 5242880
    s_mov_b32 s39, 0x20000
    s_lshl_b32 s56, s30, 7
    s_lshl_b32 s57, s3, 5
    s_add_u32 s56, s56, s57
    v_lshl_add_u32 v4, v2, 3, s56
    v_mul_u32_u24 v4, 1280, v4
    v_lshl_add_u32 v4, v3, 4, v4
    s_movk_i32 s48, 0
    buffer_load_dwordx4 v[96:99], v4, s[36:39], s48 offen offset:0 nt
    buffer_load_dwordx4 v[100:103], v4, s[36:39], s48 offen offset:256 nt
    buffer_load_dwordx4 v[104:107], v4, s[36:39], s48 offen offset:512 nt
    buffer_load_dwordx4 v[108:111], v4, s[36:39], s48 offen offset:768 nt
    s_waitcnt vmcnt(3)
    buffer_load_dwordx4 v[112:115], v4, s[36:39], s48 offen offset:1024 nt
    s_waitcnt vmcnt(3)
    s_movk_i32 s48, 1280
    buffer_load_dwordx4 v[116:119], v4, s[36:39], s48 offen offset:0 nt
    s_waitcnt vmcnt(3)
    buffer_load_dwordx4 v[120:123], v4, s[36:39], s48 offen offset:256 nt
    s_waitcnt vmcnt(3)
    buffer_load_dwordx4 v[124:127], v4, s[36:39], s48 offen offset:512 nt
    s_waitcnt vmcnt(3)
    buffer_load_dwordx4 v[128:131], v4, s[36:39], s48 offen offset:768 nt
    s_waitcnt vmcnt(3)
    buffer_load_dwordx4 v[132:135], v4, s[36:39], s48 offen offset:1024 nt
    s_waitcnt vmcnt(3)
    s_movk_i32 s48, 2560
    buffer_load_dwordx4 v[136:139], v4, s[36:39], s48 offen offset:0 nt
    s_waitcnt vmcnt(3)
    buffer_load_dwordx4 v[140:143], v4, s[36:39], s48 offen offset:256 nt
    s_waitcnt vmcnt(3)
    buffer_load_dwordx4 v[144:147], v4, s[36:39], s48 offen offset:512 nt
    s_waitcnt vmcnt(3)
    buffer_load_dwordx4 v[148:151], v4, s[36:39], s48 offen offset:768 nt
    s_waitcnt vmcnt(3)
    buffer_load_dwordx4 v[152:155], v4, s[36:39], s48 offen offset:1024 nt
    s_waitcnt vmcnt(3)
    s_movk_i32 s48, 3840
    buffer_load_dwordx4 v[156:159], v4, s[36:39], s48 offen offset:0 nt
    s_waitcnt vmcnt(3)
    buffer_load_dwordx4 v[160:163], v4, s[36:39], s48 offen offset:256 nt
    s_waitcnt vmcnt(3)
    buffer_load_dwordx4 v[164:167], v4, s[36:39], s48 offen offset:512 nt
    s_waitcnt vmcnt(3)
    buffer_load_dwordx4 v[168:171], v4, s[36:39], s48 offen offset:768 nt
    s_waitcnt vmcnt(3)
    buffer_load_dwordx4 v[172:175], v4, s[36:39], s48 offen offset:1024 nt
    s_waitcnt vmcnt(3)
    s_movk_i32 s48, 5120
    buffer_load_dwordx4 v[176:179], v4, s[36:39], s48 offen offset:0 nt
    s_waitcnt vmcnt(3)
    buffer_load_dwordx4 v[180:183], v4, s[36:39], s48 offen offset:256 nt
    s_waitcnt vmcnt(3)
    buffer_load_dwordx4 v[184:187], v4, s[36:39], s48 offen offset:512 nt
    s_waitcnt vmcnt(3)
    buffer_load_dwordx4 v[188:191], v4, s[36:39], s48 offen offset:768 nt
    s_waitcnt vmcnt(3)
    buffer_load_dwordx4 v[192:195], v4, s[36:39], s48 offen offset:1024 nt
    s_waitcnt vmcnt(3)
    s_movk_i32 s48, 6400
    buffer_load_dwordx4 v[196:199], v4, s[36:39], s48 offen offset:0 nt
    s_waitcnt vmcnt(3)
    buffer_load_dwordx4 v[200:203], v4, s[36:39], s48 offen offset:256 nt
    s_waitcnt vmcnt(3)
    buffer_load_dwordx4 v[204:207], v4, s[36:39], s48 offen offset:512 nt
    s_waitcnt vmcnt(3)
    buffer_load_dwordx4 v[208:211], v4, s[36:39], s48 offen offset:768 nt
    s_waitcnt vmcnt(3)
    buffer_load_dwordx4 v[212:215], v4, s[36:39], s48 offen offset:1024 nt
    s_waitcnt vmcnt(3)
    s_movk_i32 s48, 7680
    buffer_load_dwordx4 v[216:219], v4, s[36:39], s48 offen offset:0 nt
    s_waitcnt vmcnt(3)
    buffer_load_dwordx4 v[220:223], v4, s[36:39], s48 offen offset:256 nt
    s_waitcnt vmcnt(3)
    buffer_load_dwordx4 v[224:227], v4, s[36:39], s48 offen offset:512 nt
    s_waitcnt vmcnt(3)
    buffer_load_dwordx4 v[228:231], v4, s[36:39], s48 offen offset:768 nt
    s_waitcnt vmcnt(3)
    buffer_load_dwordx4 v[232:235], v4, s[36:39], s48 offen offset:1024 nt
    s_waitcnt vmcnt(3)
    s_movk_i32 s48, 8960
    buffer_load_dwordx4 v[236:239], v4, s[36:39], s48 offen offset:0 nt
    s_waitcnt vmcnt(3)
    buffer_load_dwordx4 v[240:243], v4, s[36:39], s48 offen offset:256 nt
    s_waitcnt vmcnt(3)
    buffer_load_dwordx4 v[244:247], v4, s[36:39], s48 offen offset:512 nt
    s_waitcnt vmcnt(3)
    buffer_load_dwordx4 v[248:251], v4, s[36:39], s48 offen offset:768 nt
    s_waitcnt vmcnt(3)
    buffer_load_dwordx4 v[252:255], v4, s[36:39], s48 offen offset:1024 nt
    s_waitcnt vmcnt(3)
    s_mov_b32 s36, s20
    s_mov_b32 s37, s21
    s_mov_b32 s38, 2211840
    s_mov_b32 s39, 0x20000
    s_cmp_lt_u32 s61, 108
    s_cbranch_scc0 L_a_nowd
    s_lshl_b32 s56, s61, 4
    s_lshl_b32 s57, s3, 2
    s_add_u32 s56, s56, s57
    v_add_u32 v4, s56, v2
    v_mul_u32_u24 v4, 1280, v4
    v_lshl_add_u32 v4, v3, 4, v4
    buffer_load_dwordx4 v[64:67], v4, s[36:39], 0 offen offset:0 nt
    buffer_load_dwordx4 v[68:71], v4, s[36:39], 0 offen offset:256 nt
    buffer_load_dwordx4 v[72:75], v4, s[36:39], 0 offen offset:512 nt
    buffer_load_dwordx4 v[76:79], v4, s[36:39], 0 offen offset:768 nt
    buffer_load_dwordx4 v[80:83], v4, s[36:39], 0 offen offset:1024 nt
L_a_nowd:
    s_cmp_eq_u32 s3, 0
    s_cbranch_scc1 L_a_all0
    v_mov_b32 v87, 0
    s_mov_b32 s49, 0
L_a_conf:
    ds_read_b32 v88, v87 offset:1040
    s_add_u32 s49, s49, 1
    s_waitcnt lgkmcnt(0)
    v_readfirstlane_b32 s56, v88
    s_cmp_ge_u32 s49, 1048576
    s_cbranch_scc1 L_a_all_done
    s_cmp_lg_u32 s56, 0
    s_cbranch_scc1 L_a_all_done
    s_sleep 4
    s_branch L_a_conf
L_a_all0:
    v_and_b32 v87, 31, v1
    v_mul_u32_u24 v87, 8, v87
    v_mov_b32 v86, 0x80000
    s_mov_b32 s49, 0
L_a_all:
    buffer_load_dword v88, v87, s[64:67], 0 offen sc1
    s_add_u32 s49, s49, 1
    s_waitcnt vmcnt(0)
    v_cmp_gt_u32 vcc, v86, v88
    s_cmp_ge_u32 s49, 65536
    s_cbranch_scc1 L_a_all_ok
    s_cbranch_vccz L_a_all_ok
    s_sleep 64
    s_branch L_a_all
L_a_all_ok:
    v_mov_b32 v87, 0
    v_mov_b32 v88, 1
    ds_write_b32 v87, v88 offset:1040
L_a_all_done:
    v_mov_b32 v24, 0
    v_mov_b32 v25, 0
    v_mov_b32 v26, 0
    v_mov_b32 v27, 0
    v_mov_b32 v28, 0
    v_mov_b32 v29, 0
    v_mov_b32 v30, 0
    v_mov_b32 v31, 0
    v_mov_b32 v32, 0
    v_mov_b32 v33, 0
    v_mov_b32 v34, 0
    v_mov_b32 v35, 0
    v_mov_b32 v36, 0
    v_mov_b32 v37, 0
    v_mov_b32 v38, 0
    v_mov_b32 v39, 0
    v_mov_b32 v40, 0
    v_mov_b32 v41, 0
    v_mov_b32 v42, 0
    v_mov_b32 v43, 0
    s_cmp_lt_u32 s61, 108
    s_cbranch_scc0 L_a_noffn2
    s_lshr_b32 s56, s61, 3
    s_lshl_b32 s56, s56, 13
    s_lshl_b32 s57, s31, 9
    s_add_u32 s56, s56, s57
    s_and_b32 s57, s61, 7
    s_lshl_b32 s57, s57, 6
    s_add_u32 s56, s56, s57
    s_lshl_b32 s57, s3, 4
    s_add_u32 s56, s56, s57
    s_add_u32 s56, s56, 925696
    v_and_b32 v86, 7, v3
    v_lshlrev_b32 v86, 10, v86
    v_lshrrev_b32 v87, 3, v3
    v_mul_u32_u24 v87, 114688, v87
    v_add_u32 v86, v86, v87
    v_lshl_add_u32 v86, v2, 2, v86
    v_mov_b32 v44, 0
    s_mov_b32 s49, 0
L_a_f1:
    buffer_load_dword v88, v86, s[40:43], s56 offen sc1
    s_add_u32 s49, s49, 1
    s_waitcnt vmcnt(0)
    v_cmp_eq_u32 vcc, -1, v88
    s_cmp_ge_u32 s49, 65536
    s_cbranch_scc1 L_a_f1_done
    s_cbranch_vccz L_a_f1_done
    s_sleep 16
    s_branch L_a_f1
L_a_f1_done:
    v_add_f32_dpp v88, v88, v88 quad_perm:[1,0,3,2] row_mask:0xf bank_mask:0xf
    s_nop 1
    v_add_f32_dpp v88, v88, v88 quad_perm:[2,3,0,1] row_mask:0xf bank_mask:0xf
    s_nop 1
    v_add_f32_dpp v88, v88, v88 row_half_mirror row_mask:0xf bank_mask:0xf
    s_nop 1
    v_mov_b32_dpp v89, v88 row_ror:8 row_mask:0xf bank_mask:0xf
    v_cvt_pk_bf16_f32 v88, v88, v88
    v_lshlrev_b32 v88, 16, v88
    v_cvt_pk_bf16_f32 v89, v89, v89
    v_lshlrev_b32 v89, 16, v89
    v_mul_f32 v90, 0xbfb8aa3b, v88
    v_exp_f32 v90, v90
    s_nop 0
    v_add_f32 v90, 1.0, v90
    v_rcp_f32 v90, v90
    s_nop 0
    v_mul_f32 v90, v90, v88
    v_cvt_pk_bf16_f32 v90, v90, v90
    v_lshlrev_b32 v90, 16, v90
    v_mul_f32 v90, v90, v89
    s_mov_b32 exec_lo, 0x00ff00ff
    s_mov_b32 exec_hi, 0x00ff00ff
    v_cvt_pk_bf16_f32 v44, v90, v90
    s_mov_b64 exec, -1
    v_perm_b32 v16, v44, v44, v8
    v_perm_b32 v17, v44, v44, v9
    v_perm_b32 v18, v44, v44, v10
    v_perm_b32 v19, v44, v44, v11
    s_nop 1
    v_mfma_f32_16x16x32_bf16 v[24:27], v[16:19], v[64:67], v[24:27]
    v_mfma_f32_16x16x32_bf16 v[28:31], v[16:19], v[68:71], v[28:31]
    v_mfma_f32_16x16x32_bf16 v[32:35], v[16:19], v[72:75], v[32:35]
    v_mfma_f32_16x16x32_bf16 v[36:39], v[16:19], v[76:79], v[36:39]
    v_mfma_f32_16x16x32_bf16 v[40:43], v[16:19], v[80:83], v[40:43]
    s_cmp_eq_u32 s31, 0
    s_cselect_b32 s56, s50, s51
    s_nop 1
    v_mul_f32 v24, s56, v24
    v_mul_f32 v25, s56, v25
    v_mul_f32 v26, s56, v26
    v_mul_f32 v27, s56, v27
    v_mul_f32 v28, s56, v28
    v_mul_f32 v29, s56, v29
    v_mul_f32 v30, s56, v30
    v_mul_f32 v31, s56, v31
    v_mul_f32 v32, s56, v32
    v_mul_f32 v33, s56, v33
    v_mul_f32 v34, s56, v34
    v_mul_f32 v35, s56, v35
    v_mul_f32 v36, s56, v36
    v_mul_f32 v37, s56, v37
    v_mul_f32 v38, s56, v38
    v_mul_f32 v39, s56, v39
    v_mul_f32 v40, s56, v40
    v_mul_f32 v41, s56, v41
    v_mul_f32 v42, s56, v42
    v_mul_f32 v43, s56, v43
L_a_noffn2:
    s_cmp_eq_u32 s31, 0
    s_cselect_b32 s68, s62, s63
    s_lshl_b32 s54, s3, 7
    v_lshl_add_u32 v6, v2, 5, s54
    v_mov_b32 v44, 0x0c0c0c0c
    v_cmp_gt_u32 vcc, 8, v3
    s_nop 1
    v_cndmask_b32 v48, v44, v8, vcc
    v_cndmask_b32 v49, v44, v9, vcc
    v_cndmask_b32 v50, v44, v10, vcc
    v_cndmask_b32 v51, v44, v11, vcc
    v_cndmask_b32 v52, v44, v12, vcc
    v_cndmask_b32 v53, v44, v13, vcc
    v_cndmask_b32 v54, v44, v14, vcc
    v_cndmask_b32 v55, v44, v15, vcc
    s_mul_i32 s54, s3, 2560
    v_lshlrev_b32 v7, 5, v3
    v_lshl_add_u32 v7, v2, 4, v7
    v_add_u32 v7, s54, v7
    s_waitcnt vmcnt(0)
    s_barrier
    ds_read_b128 v[64:67], v6 offset:2048
    ds_read_b128 v[72:75], v6 offset:2560
    ds_read_b128 v[80:83], v6 offset:3072
    ds_read_b128 v[88:91], v6 offset:3584
    ds_read_b128 v[68:71], v6 offset:2064
    ds_read_b128 v[76:79], v6 offset:2576
    ds_read_b128 v[84:87], v6 offset:3088
    ds_read_b128 v[92:95], v6 offset:3600
    s_waitcnt lgkmcnt(4)
    v_add_f32 v64, v64, v72
    v_add_f32 v80, v80, v88
    v_add_f32 v65, v65, v73
    v_add_f32 v81, v81, v89
    v_add_f32 v66, v66, v74
    v_add_f32 v82, v82, v90
    v_add_f32 v67, v67, v75
    v_add_f32 v83, v83, v91
    v_add_f32 v64, v64, v80
    v_add_f32 v65, v65, v81
    v_add_f32 v66, v66, v82
    v_add_f32 v67, v67, v83
    v_cvt_pk_bf16_f32 v44, v64, v65
    v_cvt_pk_bf16_f32 v45, v66, v67
    v_perm_b32 v16, v44, v44, v48
    v_perm_b32 v17, v44, v44, v49
    v_perm_b32 v18, v44, v44, v50
    v_perm_b32 v19, v44, v44, v51
    s_nop 1
    v_mfma_f32_16x16x32_bf16 v[24:27], v[16:19], v[96:99], v[24:27]
    v_perm_b32 v20, v44, v44, v52
    v_mfma_f32_16x16x32_bf16 v[28:31], v[16:19], v[100:103], v[28:31]
    v_perm_b32 v21, v44, v44, v53
    v_mfma_f32_16x16x32_bf16 v[32:35], v[16:19], v[104:107], v[32:35]
    v_perm_b32 v22, v44, v44, v54
    v_mfma_f32_16x16x32_bf16 v[36:39], v[16:19], v[108:111], v[36:39]
    v_perm_b32 v23, v44, v44, v55
    v_mfma_f32_16x16x32_bf16 v[40:43], v[16:19], v[112:115], v[40:43]
    s_nop 0
    v_mfma_f32_16x16x32_bf16 v[24:27], v[20:23], v[116:119], v[24:27]
    s_waitcnt lgkmcnt(0)
    v_add_f32 v68, v68, v76
    v_add_f32 v84, v84, v92
    v_add_f32 v69, v69, v77
    v_add_f32 v85, v85, v93
    v_add_f32 v70, v70, v78
    v_add_f32 v86, v86, v94
    v_add_f32 v71, v71, v79
    v_add_f32 v87, v87, v95
    v_add_f32 v68, v68, v84
    v_add_f32 v69, v69, v85
    v_add_f32 v70, v70, v86
    v_add_f32 v71, v71, v87
    v_cvt_pk_bf16_f32 v46, v68, v69
    v_cvt_pk_bf16_f32 v47, v70, v71
    v_perm_b32 v16, v45, v45, v48
    v_mfma_f32_16x16x32_bf16 v[28:31], v[20:23], v[120:123], v[28:31]
    v_perm_b32 v17, v45, v45, v49
    v_mfma_f32_16x16x32_bf16 v[32:35], v[20:23], v[124:127], v[32:35]
    v_perm_b32 v18, v45, v45, v50
    v_mfma_f32_16x16x32_bf16 v[36:39], v[20:23], v[128:131], v[36:39]
    v_perm_b32 v19, v45, v45, v51
    v_mfma_f32_16x16x32_bf16 v[40:43], v[20:23], v[132:135], v[40:43]
    s_nop 0
    v_mfma_f32_16x16x32_bf16 v[24:27], v[16:19], v[136:139], v[24:27]
    v_perm_b32 v20, v45, v45, v52
    v_mfma_f32_16x16x32_bf16 v[28:31], v[16:19], v[140:143], v[28:31]
    v_perm_b32 v21, v45, v45, v53
    v_mfma_f32_16x16x32_bf16 v[32:35], v[16:19], v[144:147], v[32:35]
    v_perm_b32 v22, v45, v45, v54
    v_mfma_f32_16x16x32_bf16 v[36:39], v[16:19], v[148:151], v[36:39]
    v_perm_b32 v23, v45, v45, v55
    v_mfma_f32_16x16x32_bf16 v[40:43], v[16:19], v[152:155], v[40:43]
    s_nop 0
    v_mfma_f32_16x16x32_bf16 v[24:27], v[20:23], v[156:159], v[24:27]
    v_perm_b32 v16, v46, v46, v48
    v_mfma_f32_16x16x32_bf16 v[28:31], v[20:23], v[160:163], v[28:31]
    v_perm_b32 v17, v46, v46, v49
    v_mfma_f32_16x16x32_bf16 v[32:35], v[20:23], v[164:167], v[32:35]
    v_perm_b32 v18, v46, v46, v50
    v_mfma_f32_16x16x32_bf16 v[36:39], v[20:23], v[168:171], v[36:39]
    v_perm_b32 v19, v46, v46, v51
    v_mfma_f32_16x16x32_bf16 v[40:43], v[20:23], v[172:175], v[40:43]
    s_nop 0
    v_mfma_f32_16x16x32_bf16 v[24:27], v[16:19], v[176:179], v[24:27]
    v_perm_b32 v20, v46, v46, v52
    v_mfma_f32_16x16x32_bf16 v[28:31], v[16:19], v[180:183], v[28:31]
    v_perm_b32 v21, v46, v46, v53
    v_mfma_f32_16x16x32_bf16 v[32:35], v[16:19], v[184:187], v[32:35]
    v_perm_b32 v22, v46, v46, v54
    v_mfma_f32_16x16x32_bf16 v[36:39], v[16:19], v[188:191], v[36:39]
    v_perm_b32 v23, v46, v46, v55
    v_mfma_f32_16x16x32_bf16 v[40:43], v[16:19], v[192:195], v[40:43]
    s_nop 0
    v_mfma_f32_16x16x32_bf16 v[24:27], v[20:23], v[196:199], v[24:27]
    v_perm_b32 v16, v47, v47, v48
    v_mfma_f32_16x16x32_bf16 v[28:31], v[20:23], v[200:203], v[28:31]
    v_perm_b32 v17, v47, v47, v49
    v_mfma_f32_16x16x32_bf16 v[32:35], v[20:23], v[204:207], v[32:35]
    v_perm_b32 v18, v47, v47, v50
    v_mfma_f32_16x16x32_bf16 v[36:39], v[20:23], v[208:211], v[36:39]
    v_perm_b32 v19, v47, v47, v51
    v_mfma_f32_16x16x32_bf16 v[40:43], v[20:23], v[212:215], v[40:43]
    s_nop 0
    v_mfma_f32_16x16x32_bf16 v[24:27], v[16:19], v[216:219], v[24:27]
    v_perm_b32 v20, v47, v47, v52
    v_mfma_f32_16x16x32_bf16 v[28:31], v[16:19], v[220:223], v[28:31]
    v_perm_b32 v21, v47, v47, v53
    v_mfma_f32_16x16x32_bf16 v[32:35], v[16:19], v[224:227], v[32:35]
    v_perm_b32 v22, v47, v47, v54
    v_mfma_f32_16x16x32_bf16 v[36:39], v[16:19], v[228:231], v[36:39]
    v_perm_b32 v23, v47, v47, v55
    v_mfma_f32_16x16x32_bf16 v[40:43], v[16:19], v[232:235], v[40:43]
    s_nop 0
    v_mfma_f32_16x16x32_bf16 v[24:27], v[20:23], v[236:239], v[24:27]
    v_mfma_f32_16x16x32_bf16 v[28:31], v[20:23], v[240:243], v[28:31]
    v_mfma_f32_16x16x32_bf16 v[32:35], v[20:23], v[244:247], v[32:35]
    v_mfma_f32_16x16x32_bf16 v[36:39], v[20:23], v[248:251], v[36:39]
    v_mfma_f32_16x16x32_bf16 v[40:43], v[20:23], v[252:255], v[40:43]
    s_mov_b32 exec_hi, 0
    s_nop 2
    ds_write_b128 v7, v[24:27] offset:4096
    ds_write_b128 v7, v[28:31] offset:4608
    ds_write_b128 v7, v[32:35] offset:5120
    ds_write_b128 v7, v[36:39] offset:5632
    ds_write_b128 v7, v[40:43] offset:6144
    s_mov_b32 exec_hi, -1
    s_waitcnt lgkmcnt(0)
    s_barrier
    s_branch L_pub
L_stream:
    s_sub_u32 s57, s3, 4
    s_lshl_b32 s56, s33, 21
    s_lshl_b32 s58, s32, 19
    s_add_u32 s56, s56, s58
    v_lshlrev_b32 v4, 4, v1
    s_lshr_b32 s58, s2, 3
    s_mul_i32 s58, s58, 1
    s_and_b32 s59, s2, 7
    s_mul_i32 s59, s59, 0
    s_add_u32 s58, s58, s59
    s_lshl_b32 s58, s58, 14
    s_lshl_b32 s59, s57, 12
    s_add_u32 s48, s58, s59
    s_and_b32 s48, s48, 0x7ffff
    v_mov_b32 v14, 0x7fff0000
    s_lshl_b32 s59, s34, 2
    s_add_u32 s59, s59, s57
    s_lshl_b32 s59, s59, 7
    s_add_u32 s59, s59, 1679360
    v_lshl_add_u32 v47, v1, 3, s59
    v_cmp_gt_u32 vcc, 16, v1
    s_nop 1
    v_cndmask_b32 v47, v14, v47, vcc
    s_waitcnt lgkmcnt(0)
    s_add_u32 s36, s6, s56
    s_addc_u32 s37, s7, 0
    s_mov_b32 s38, 0x80000
    s_mov_b32 s39, 0x20000
    s_add_u32 s44, s8, s56
    s_addc_u32 s45, s9, 0
    s_mov_b32 s40, s28
    s_mov_b32 s41, s29
    s_mov_b32 s42, 0x1ba000
    s_mov_b32 s43, 0x20000
    s_mov_b32 s64, s26
    s_mov_b32 s65, s27
    s_mov_b32 s66, 256
    s_mov_b32 s67, 0x20000
    buffer_load_dwordx4 v[128:131], v4, s[36:39], s48 offen offset:0 nt
    buffer_load_dwordx4 v[132:135], v4, s[36:39], s48 offen offset:1024 nt
    buffer_load_dwordx4 v[136:139], v4, s[36:39], s48 offen offset:2048 nt
    buffer_load_dwordx4 v[140:143], v4, s[36:39], s48 offen offset:3072 nt
    s_add_u32 s48, s48, 0x4000
    s_and_b32 s48, s48, 0x7ffff
    buffer_load_dwordx4 v[144:147], v4, s[36:39], s48 offen offset:0 nt
    buffer_load_dwordx4 v[148:151], v4, s[36:39], s48 offen offset:1024 nt
    buffer_load_dwordx4 v[152:155], v4, s[36:39], s48 offen offset:2048 nt
    s_waitcnt vmcnt(6)
    buffer_load_dwordx4 v[156:159], v4, s[36:39], s48 offen offset:3072 nt
    s_add_u32 s48, s48, 0x4000
    s_and_b32 s48, s48, 0x7ffff
    s_waitcnt vmcnt(6)
    buffer_load_dwordx4 v[160:163], v4, s[36:39], s48 offen offset:0 nt
    s_waitcnt vmcnt(6)
    buffer_load_dwordx4 v[164:167], v4, s[36:39], s48 offen offset:1024 nt
    s_waitcnt vmcnt(6)
    buffer_load_dwordx4 v[168:171], v4, s[36:39], s48 offen offset:2048 nt
    s_waitcnt vmcnt(6)
    buffer_load_dwordx4 v[172:175], v4, s[36:39], s48 offen offset:3072 nt
    s_add_u32 s48, s48, 0x4000
    s_and_b32 s48, s48, 0x7ffff
    s_waitcnt vmcnt(6)
    buffer_load_dwordx4 v[176:179], v4, s[36:39], s48 offen offset:0 nt
    s_waitcnt vmcnt(6)
    buffer_load_dwordx4 v[180:183], v4, s[36:39], s48 offen offset:1024 nt
    s_waitcnt vmcnt(6)
    buffer_load_dwordx4 v[184:187], v4, s[36:39], s48 offen offset:2048 nt
    s_waitcnt vmcnt(6)
    buffer_load_dwordx4 v[188:191], v4, s[36:39], s48 offen offset:3072 nt
    s_add_u32 s48, s48, 0x4000
    s_and_b32 s48, s48, 0x7ffff
    s_waitcnt vmcnt(6)
    buffer_load_dwordx4 v[192:195], v4, s[36:39], s48 offen offset:0 nt
    s_waitcnt vmcnt(6)
    buffer_load_dwordx4 v[196:199], v4, s[36:39], s48 offen offset:1024 nt
    s_waitcnt vmcnt(6)
    buffer_load_dwordx4 v[200:203], v4, s[36:39], s48 offen offset:2048 nt
    s_waitcnt vmcnt(6)
    buffer_load_dwordx4 v[204:207], v4, s[36:39], s48 offen offset:3072 nt
    s_add_u32 s48, s48, 0x4000
    s_and_b32 s48, s48, 0x7ffff
    s_waitcnt vmcnt(6)
    buffer_load_dwordx4 v[208:211], v4, s[36:39], s48 offen offset:0 nt
    s_waitcnt vmcnt(6)
    buffer_load_dwordx4 v[212:215], v4, s[36:39], s48 offen offset:1024 nt
    s_waitcnt vmcnt(6)
    buffer_load_dwordx4 v[216:219], v4, s[36:39], s48 offen offset:2048 nt
    s_waitcnt vmcnt(6)
    buffer_load_dwordx4 v[220:223], v4, s[36:39], s48 offen offset:3072 nt
    s_add_u32 s48, s48, 0x4000
    s_and_b32 s48, s48, 0x7ffff
    s_waitcnt vmcnt(6)
    buffer_load_dwordx4 v[224:227], v4, s[36:39], s48 offen offset:0 nt
    s_waitcnt vmcnt(6)
    buffer_load_dwordx4 v[228:231], v4, s[36:39], s48 offen offset:1024 nt
    s_waitcnt vmcnt(6)
    buffer_load_dwordx4 v[232:235], v4, s[36:39], s48 offen offset:2048 nt
    s_waitcnt vmcnt(6)
    buffer_load_dwordx4 v[236:239], v4, s[36:39], s48 offen offset:3072 nt
    s_add_u32 s48, s48, 0x4000
    s_and_b32 s48, s48, 0x7ffff
    s_waitcnt vmcnt(6)
    buffer_load_dwordx4 v[240:243], v4, s[36:39], s48 offen offset:0 nt
    s_waitcnt vmcnt(6)
    buffer_load_dwordx4 v[244:247], v4, s[36:39], s48 offen offset:1024 nt
    s_waitcnt vmcnt(6)
    buffer_load_dwordx4 v[248:251], v4, s[36:39], s48 offen offset:2048 nt
    s_waitcnt vmcnt(6)
    buffer_load_dwordx4 v[252:255], v4, s[36:39], s48 offen offset:3072 nt
    s_add_u32 s48, s48, 0x4000
    s_and_b32 s48, s48, 0x7ffff
    v_and_b32 v32, 1, v3
    v_mov_b32 v33, 0xffff
    v_mov_b32 v34, 0xffff0000
    v_cmp_eq_u32 vcc, 1, v32
    s_nop 1
    v_cndmask_b32 v33, v33, v34, vcc
    v_lshrrev_b32 v32, 1, v3
    v_cmp_eq_u32 vcc, 0, v32
    s_nop 1
    v_cndmask_b32 v16, 0, v33, vcc
    v_cmp_eq_u32 vcc, 1, v32
    s_nop 1
    v_cndmask_b32 v17, 0, v33, vcc
    v_cmp_eq_u32 vcc, 2, v32
    s_nop 1
    v_cndmask_b32 v18, 0, v33, vcc
    v_cmp_eq_u32 vcc, 3, v32
    s_nop 1
    v_cndmask_b32 v19, 0, v33, vcc
    s_mov_b32 s50, 0xaaaaaaaa
    s_mov_b32 s51, 0xaaaaaaaa
    s_mov_b32 s52, 0xcccccccc
    s_mov_b32 s53, 0xcccccccc
    v_lshlrev_b32 v46, 4, v3
    s_barrier
    ds_read_b128 v[80:83], v46 offset:0
    s_lshl_b32 s59, s31, 2
    v_mov_b32 v56, s59
    ds_read_b32 v56, v56 offset:1024
    s_mov_b32 s49, 0
    s_waitcnt lgkmcnt(0)
L_kloop:
    v_mov_b32 v32, 0
    v_dot2c_f32_bf16 v32, v128, v80
    v_dot2c_f32_bf16 v32, v129, v81
    v_dot2c_f32_bf16 v32, v130, v82
    v_dot2c_f32_bf16 v32, v131, v83
    s_waitcnt vmcnt(6)
    buffer_load_dwordx4 v[128:131], v4, s[36:39], s48 offen offset:0 nt
    v_mov_b32 v33, 0
    v_dot2c_f32_bf16 v33, v132, v80
    v_dot2c_f32_bf16 v33, v133, v81
    v_dot2c_f32_bf16 v33, v134, v82
    v_dot2c_f32_bf16 v33, v135, v83
    s_waitcnt vmcnt(6)
    buffer_load_dwordx4 v[132:135], v4, s[36:39], s48 offen offset:1024 nt
    v_add_f32_dpp v36, v32, v32 row_ror:8 row_mask:0xf bank_mask:0x3
    s_nop 1
    v_add_f32_dpp v36, v33, v33 row_ror:8 row_mask:0xf bank_mask:0xc
    v_mov_b32 v32, 0
    v_dot2c_f32_bf16 v32, v136, v80
    v_dot2c_f32_bf16 v32, v137, v81
    v_dot2c_f32_bf16 v32, v138, v82
    v_dot2c_f32_bf16 v32, v139, v83
    s_waitcnt vmcnt(6)
    buffer_load_dwordx4 v[136:139], v4, s[36:39], s48 offen offset:2048 nt
    v_mov_b32 v33, 0
    v_dot2c_f32_bf16 v33, v140, v80
    v_dot2c_f32_bf16 v33, v141, v81
    v_dot2c_f32_bf16 v33, v142, v82
    v_dot2c_f32_bf16 v33, v143, v83
    s_waitcnt vmcnt(6)
    buffer_load_dwordx4 v[140:143], v4, s[36:39], s48 offen offset:3072 nt
    s_add_u32 s48, s48, 0x4000
    s_and_b32 s48, s48, 0x7ffff
    v_add_f32_dpp v37, v32, v32 row_ror:8 row_mask:0xf bank_mask:0x3
    s_nop 1
    v_add_f32_dpp v37, v33, v33 row_ror:8 row_mask:0xf bank_mask:0xc
    v_add_f32_dpp v38, v36, v36 row_shl:4 row_mask:0xf bank_mask:0x5
    s_nop 1
    v_add_f32_dpp v38, v37, v37 row_shr:4 row_mask:0xf bank_mask:0xa
    v_mov_b32 v32, 0
    v_dot2c_f32_bf16 v32, v144, v80
    v_dot2c_f32_bf16 v32, v145, v81
    v_dot2c_f32_bf16 v32, v146, v82
    v_dot2c_f32_bf16 v32, v147, v83
    s_waitcnt vmcnt(6)
    buffer_load_dwordx4 v[144:147], v4, s[36:39], s48 offen offset:0 nt
    v_mov_b32 v33, 0
    v_dot2c_f32_bf16 v33, v148, v80
    v_dot2c_f32_bf16 v33, v149, v81
    v_dot2c_f32_bf16 v33, v150, v82
    v_dot2c_f32_bf16 v33, v151, v83
    s_waitcnt vmcnt(6)
    buffer_load_dwordx4 v[148:151], v4, s[36:39], s48 offen offset:1024 nt
    v_add_f32_dpp v36, v32, v32 row_ror:8 row_mask:0xf bank_mask:0x3
    s_nop 1
    v_add_f32_dpp v36, v33, v33 row_ror:8 row_mask:0xf bank_mask:0xc
    v_mov_b32 v32, 0
    v_dot2c_f32_bf16 v32, v152, v80
    v_dot2c_f32_bf16 v32, v153, v81
    v_dot2c_f32_bf16 v32, v154, v82
    v_dot2c_f32_bf16 v32, v155, v83
    s_waitcnt vmcnt(6)
    buffer_load_dwordx4 v[152:155], v4, s[36:39], s48 offen offset:2048 nt
    v_mov_b32 v33, 0
    v_dot2c_f32_bf16 v33, v156, v80
    v_dot2c_f32_bf16 v33, v157, v81
    v_dot2c_f32_bf16 v33, v158, v82
    v_dot2c_f32_bf16 v33, v159, v83
    s_waitcnt vmcnt(6)
    buffer_load_dwordx4 v[156:159], v4, s[36:39], s48 offen offset:3072 nt
    s_add_u32 s48, s48, 0x4000
    s_and_b32 s48, s48, 0x7ffff
    v_add_f32_dpp v37, v32, v32 row_ror:8 row_mask:0xf bank_mask:0x3
    s_nop 1
    v_add_f32_dpp v37, v33, v33 row_ror:8 row_mask:0xf bank_mask:0xc
    v_add_f32_dpp v39, v36, v36 row_shl:4 row_mask:0xf bank_mask:0x5
    s_nop 1
    v_add_f32_dpp v39, v37, v37 row_shr:4 row_mask:0xf bank_mask:0xa
    v_add_f32_dpp v42, v38, v38 quad_perm:[2,3,0,1] row_mask:0xf bank_mask:0xf
    s_nop 0
    v_add_f32_dpp v43, v39, v39 quad_perm:[2,3,0,1] row_mask:0xf bank_mask:0xf
    v_cndmask_b32 v40, v42, v43, s[52:53]
    v_mov_b32 v32, 0
    v_dot2c_f32_bf16 v32, v160, v80
    v_dot2c_f32_bf16 v32, v161, v81
    v_dot2c_f32_bf16 v32, v162, v82
    v_dot2c_f32_bf16 v32, v163, v83
    s_waitcnt vmcnt(6)
    buffer_load_dwordx4 v[160:163], v4, s[36:39], s48 offen offset:0 nt
    v_mov_b32 v33, 0
    v_dot2c_f32_bf16 v33, v164, v80
    v_dot2c_f32_bf16 v33, v165, v81
    v_dot2c_f32_bf16 v33, v166, v82
    v_dot2c_f32_bf16 v33, v167, v83
    s_waitcnt vmcnt(6)
    buffer_load_dwordx4 v[164:167], v4, s[36:39], s48 offen offset:1024 nt
    v_add_f32_dpp v36, v32, v32 row_ror:8 row_mask:0xf bank_mask:0x3
    s_nop 1
    v_add_f32_dpp v36, v33, v33 row_ror:8 row_mask:0xf bank_mask:0xc
    v_mov_b32 v32, 0
    v_dot2c_f32_bf16 v32, v168, v80
    v_dot2c_f32_bf16 v32, v169, v81
    v_dot2c_f32_bf16 v32, v170, v82
    v_dot2c_f32_bf16 v32, v171, v83
    s_waitcnt vmcnt(6)
    buffer_load_dwordx4 v[168:171], v4, s[36:39], s48 offen offset:2048 nt
    v_mov_b32 v33, 0
    v_dot2c_f32_bf16 v33, v172, v80
    v_dot2c_f32_bf16 v33, v173, v81
    v_dot2c_f32_bf16 v33, v174, v82
    v_dot2c_f32_bf16 v33, v175, v83
    s_waitcnt vmcnt(6)
    buffer_load_dwordx4 v[172:175], v4, s[36:39], s48 offen offset:3072 nt
    s_add_u32 s48, s48, 0x4000
    s_and_b32 s48, s48, 0x7ffff
    v_add_f32_dpp v37, v32, v32 row_ror:8 row_mask:0xf bank_mask:0x3
    s_nop 1
    v_add_f32_dpp v37, v33, v33 row_ror:8 row_mask:0xf bank_mask:0xc
    v_add_f32_dpp v34, v36, v36 row_shl:4 row_mask:0xf bank_mask:0x5
    s_nop 1
    v_add_f32_dpp v34, v37, v37 row_shr:4 row_mask:0xf bank_mask:0xa
    v_mov_b32 v32, 0
    v_dot2c_f32_bf16 v32, v176, v80
    v_dot2c_f32_bf16 v32, v177, v81
    v_dot2c_f32_bf16 v32, v178, v82
    v_dot2c_f32_bf16 v32, v179, v83
    s_waitcnt vmcnt(6)
    buffer_load_dwordx4 v[176:179], v4, s[36:39], s48 offen offset:0 nt
    v_mov_b32 v33, 0
    v_dot2c_f32_bf16 v33, v180, v80
    v_dot2c_f32_bf16 v33, v181, v81
    v_dot2c_f32_bf16 v33, v182, v82
    v_dot2c_f32_bf16 v33, v183, v83
    s_waitcnt vmcnt(6)
    buffer_load_dwordx4 v[180:183], v4, s[36:39], s48 offen offset:1024 nt
    v_add_f32_dpp v36, v32, v32 row_ror:8 row_mask:0xf bank_mask:0x3
    s_nop 1
    v_add_f32_dpp v36, v33, v33 row_ror:8 row_mask:0xf bank_mask:0xc
    v_mov_b32 v32, 0
    v_dot2c_f32_bf16 v32, v184, v80
    v_dot2c_f32_bf16 v32, v185, v81
    v_dot2c_f32_bf16 v32, v186, v82
    v_dot2c_f32_bf16 v32, v187, v83
    s_waitcnt vmcnt(6)
    buffer_load_dwordx4 v[184:187], v4, s[36:39], s48 offen offset:2048 nt
    v_mov_b32 v33, 0
    v_dot2c_f32_bf16 v33, v188, v80
    v_dot2c_f32_bf16 v33, v189, v81
    v_dot2c_f32_bf16 v33, v190, v82
    v_dot2c_f32_bf16 v33, v191, v83
    s_waitcnt vmcnt(6)
    buffer_load_dwordx4 v[188:191], v4, s[36:39], s48 offen offset:3072 nt
    s_add_u32 s48, s48, 0x4000
    s_and_b32 s48, s48, 0x7ffff
    v_add_f32_dpp v37, v32, v32 row_ror:8 row_mask:0xf bank_mask:0x3
    s_nop 1
    v_add_f32_dpp v37, v33, v33 row_ror:8 row_mask:0xf bank_mask:0xc
    v_add_f32_dpp v35, v36, v36 row_shl:4 row_mask:0xf bank_mask:0x5
    s_nop 1
    v_add_f32_dpp v35, v37, v37 row_shr:4 row_mask:0xf bank_mask:0xa
    v_add_f32_dpp v42, v34, v34 quad_perm:[2,3,0,1] row_mask:0xf bank_mask:0xf
    s_nop 0
    v_add_f32_dpp v43, v35, v35 quad_perm:[2,3,0,1] row_mask:0xf bank_mask:0xf
    v_cndmask_b32 v41, v42, v43, s[52:53]
    v_add_f32_dpp v42, v40, v40 quad_perm:[1,0,3,2] row_mask:0xf bank_mask:0xf
    s_nop 0
    v_add_f32_dpp v43, v41, v41 quad_perm:[1,0,3,2] row_mask:0xf bank_mask:0xf
    v_cndmask_b32 v44, v42, v43, s[50:51]
    v_mov_b32 v32, 0
    v_dot2c_f32_bf16 v32, v192, v80
    v_dot2c_f32_bf16 v32, v193, v81
    v_dot2c_f32_bf16 v32, v194, v82
    v_dot2c_f32_bf16 v32, v195, v83
    s_waitcnt vmcnt(6)
    buffer_load_dwordx4 v[192:195], v4, s[36:39], s48 offen offset:0 nt
    v_mov_b32 v33, 0
    v_dot2c_f32_bf16 v33, v196, v80
    v_dot2c_f32_bf16 v33, v197, v81
    v_dot2c_f32_bf16 v33, v198, v82
    v_dot2c_f32_bf16 v33, v199, v83
    s_waitcnt vmcnt(6)
    buffer_load_dwordx4 v[196:199], v4, s[36:39], s48 offen offset:1024 nt
    v_add_f32_dpp v36, v32, v32 row_ror:8 row_mask:0xf bank_mask:0x3
    s_nop 1
    v_add_f32_dpp v36, v33, v33 row_ror:8 row_mask:0xf bank_mask:0xc
    v_mov_b32 v32, 0
    v_dot2c_f32_bf16 v32, v200, v80
    v_dot2c_f32_bf16 v32, v201, v81
    v_dot2c_f32_bf16 v32, v202, v82
    v_dot2c_f32_bf16 v32, v203, v83
    s_waitcnt vmcnt(6)
    buffer_load_dwordx4 v[200:203], v4, s[36:39], s48 offen offset:2048 nt
    v_mov_b32 v33, 0
    v_dot2c_f32_bf16 v33, v204, v80
    v_dot2c_f32_bf16 v33, v205, v81
    v_dot2c_f32_bf16 v33, v206, v82
    v_dot2c_f32_bf16 v33, v207, v83
    s_waitcnt vmcnt(6)
    buffer_load_dwordx4 v[204:207], v4, s[36:39], s48 offen offset:3072 nt
    s_add_u32 s48, s48, 0x4000
    s_and_b32 s48, s48, 0x7ffff
    v_add_f32_dpp v37, v32, v32 row_ror:8 row_mask:0xf bank_mask:0x3
    s_nop 1
    v_add_f32_dpp v37, v33, v33 row_ror:8 row_mask:0xf bank_mask:0xc
    v_add_f32_dpp v38, v36, v36 row_shl:4 row_mask:0xf bank_mask:0x5
    s_nop 1
    v_add_f32_dpp v38, v37, v37 row_shr:4 row_mask:0xf bank_mask:0xa
    v_mov_b32 v32, 0
    v_dot2c_f32_bf16 v32, v208, v80
    v_dot2c_f32_bf16 v32, v209, v81
    v_dot2c_f32_bf16 v32, v210, v82
    v_dot2c_f32_bf16 v32, v211, v83
    s_waitcnt vmcnt(6)
    buffer_load_dwordx4 v[208:211], v4, s[36:39], s48 offen offset:0 nt
    v_mov_b32 v33, 0
    v_dot2c_f32_bf16 v33, v212, v80
    v_dot2c_f32_bf16 v33, v213, v81
    v_dot2c_f32_bf16 v33, v214, v82
    v_dot2c_f32_bf16 v33, v215, v83
    s_waitcnt vmcnt(6)
    buffer_load_dwordx4 v[212:215], v4, s[36:39], s48 offen offset:1024 nt
    v_add_f32_dpp v36, v32, v32 row_ror:8 row_mask:0xf bank_mask:0x3
    s_nop 1
    v_add_f32_dpp v36, v33, v33 row_ror:8 row_mask:0xf bank_mask:0xc
    v_mov_b32 v32, 0
    v_dot2c_f32_bf16 v32, v216, v80
    v_dot2c_f32_bf16 v32, v217, v81
    v_dot2c_f32_bf16 v32, v218, v82
    v_dot2c_f32_bf16 v32, v219, v83
    s_waitcnt vmcnt(6)
    buffer_load_dwordx4 v[216:219], v4, s[36:39], s48 offen offset:2048 nt
    v_mov_b32 v33, 0
    v_dot2c_f32_bf16 v33, v220, v80
    v_dot2c_f32_bf16 v33, v221, v81
    v_dot2c_f32_bf16 v33, v222, v82
    v_dot2c_f32_bf16 v33, v223, v83
    s_waitcnt vmcnt(6)
    buffer_load_dwordx4 v[220:223], v4, s[36:39], s48 offen offset:3072 nt
    s_add_u32 s48, s48, 0x4000
    s_and_b32 s48, s48, 0x7ffff
    v_add_f32_dpp v37, v32, v32 row_ror:8 row_mask:0xf bank_mask:0x3
    s_nop 1
    v_add_f32_dpp v37, v33, v33 row_ror:8 row_mask:0xf bank_mask:0xc
    v_add_f32_dpp v39, v36, v36 row_shl:4 row_mask:0xf bank_mask:0x5
    s_nop 1
    v_add_f32_dpp v39, v37, v37 row_shr:4 row_mask:0xf bank_mask:0xa
    v_add_f32_dpp v42, v38, v38 quad_perm:[2,3,0,1] row_mask:0xf bank_mask:0xf
    s_nop 0
    v_add_f32_dpp v43, v39, v39 quad_perm:[2,3,0,1] row_mask:0xf bank_mask:0xf
    v_cndmask_b32 v40, v42, v43, s[52:53]
    v_mov_b32 v32, 0
    v_dot2c_f32_bf16 v32, v224, v80
    v_dot2c_f32_bf16 v32, v225, v81
    v_dot2c_f32_bf16 v32, v226, v82
    v_dot2c_f32_bf16 v32, v227, v83
    s_waitcnt vmcnt(6)
    buffer_load_dwordx4 v[224:227], v4, s[36:39], s48 offen offset:0 nt
    v_mov_b32 v33, 0
    v_dot2c_f32_bf16 v33, v228, v80
    v_dot2c_f32_bf16 v33, v229, v81
    v_dot2c_f32_bf16 v33, v230, v82
    v_dot2c_f32_bf16 v33, v231, v83
    s_waitcnt vmcnt(6)
    buffer_load_dwordx4 v[228:231], v4, s[36:39], s48 offen offset:1024 nt
    v_add_f32_dpp v36, v32, v32 row_ror:8 row_mask:0xf bank_mask:0x3
    s_nop 1
    v_add_f32_dpp v36, v33, v33 row_ror:8 row_mask:0xf bank_mask:0xc
    v_mov_b32 v32, 0
    v_dot2c_f32_bf16 v32, v232, v80
    v_dot2c_f32_bf16 v32, v233, v81
    v_dot2c_f32_bf16 v32, v234, v82
    v_dot2c_f32_bf16 v32, v235, v83
    s_waitcnt vmcnt(6)
    buffer_load_dwordx4 v[232:235], v4, s[36:39], s48 offen offset:2048 nt
    v_mov_b32 v33, 0
    v_dot2c_f32_bf16 v33, v236, v80
    v_dot2c_f32_bf16 v33, v237, v81
    v_dot2c_f32_bf16 v33, v238, v82
    v_dot2c_f32_bf16 v33, v239, v83
    s_waitcnt vmcnt(6)
    buffer_load_dwordx4 v[236:239], v4, s[36:39], s48 offen offset:3072 nt
    s_add_u32 s48, s48, 0x4000
    s_and_b32 s48, s48, 0x7ffff
    v_add_f32_dpp v37, v32, v32 row_ror:8 row_mask:0xf bank_mask:0x3
    s_nop 1
    v_add_f32_dpp v37, v33, v33 row_ror:8 row_mask:0xf bank_mask:0xc
    v_add_f32_dpp v34, v36, v36 row_shl:4 row_mask:0xf bank_mask:0x5
    s_nop 1
    v_add_f32_dpp v34, v37, v37 row_shr:4 row_mask:0xf bank_mask:0xa
    v_mov_b32 v32, 0
    v_dot2c_f32_bf16 v32, v240, v80
    v_dot2c_f32_bf16 v32, v241, v81
    v_dot2c_f32_bf16 v32, v242, v82
    v_dot2c_f32_bf16 v32, v243, v83
    s_waitcnt vmcnt(6)
    buffer_load_dwordx4 v[240:243], v4, s[36:39], s48 offen offset:0 nt
    v_mov_b32 v33, 0
    v_dot2c_f32_bf16 v33, v244, v80
    v_dot2c_f32_bf16 v33, v245, v81
    v_dot2c_f32_bf16 v33, v246, v82
    v_dot2c_f32_bf16 v33, v247, v83
    s_waitcnt vmcnt(6)
    buffer_load_dwordx4 v[244:247], v4, s[36:39], s48 offen offset:1024 nt
    v_add_f32_dpp v36, v32, v32 row_ror:8 row_mask:0xf bank_mask:0x3
    s_nop 1
    v_add_f32_dpp v36, v33, v33 row_ror:8 row_mask:0xf bank_mask:0xc
    v_mov_b32 v32, 0
    v_dot2c_f32_bf16 v32, v248, v80
    v_dot2c_f32_bf16 v32, v249, v81
    v_dot2c_f32_bf16 v32, v250, v82
    v_dot2c_f32_bf16 v32, v251, v83
    s_waitcnt vmcnt(6)
    buffer_load_dwordx4 v[248:251], v4, s[36:39], s48 offen offset:2048 nt
    v_mov_b32 v33, 0
    v_dot2c_f32_bf16 v33, v252, v80
    v_dot2c_f32_bf16 v33, v253, v81
    v_dot2c_f32_bf16 v33, v254, v82
    v_dot2c_f32_bf16 v33, v255, v83
    s_waitcnt vmcnt(6)
    buffer_load_dwordx4 v[252:255], v4, s[36:39], s48 offen offset:3072 nt
    s_add_u32 s48, s48, 0x4000
    s_and_b32 s48, s48, 0x7ffff
    v_add_f32_dpp v37, v32, v32 row_ror:8 row_mask:0xf bank_mask:0x3
    s_nop 1
    v_add_f32_dpp v37, v33, v33 row_ror:8 row_mask:0xf bank_mask:0xc
    v_add_f32_dpp v35, v36, v36 row_shl:4 row_mask:0xf bank_mask:0x5
    s_nop 1
    v_add_f32_dpp v35, v37, v37 row_shr:4 row_mask:0xf bank_mask:0xa
    v_add_f32_dpp v42, v34, v34 quad_perm:[2,3,0,1] row_mask:0xf bank_mask:0xf
    s_nop 0
    v_add_f32_dpp v43, v35, v35 quad_perm:[2,3,0,1] row_mask:0xf bank_mask:0xf
    v_cndmask_b32 v41, v42, v43, s[52:53]
    v_add_f32_dpp v42, v40, v40 quad_perm:[1,0,3,2] row_mask:0xf bank_mask:0xf
    s_nop 0
    v_add_f32_dpp v43, v41, v41 quad_perm:[1,0,3,2] row_mask:0xf bank_mask:0xf
    v_cndmask_b32 v45, v42, v43, s[50:51]
    v_mov_b32 v8, v10
    v_mov_b32 v9, v11
    v_mov_b32 v10, v12
    v_mov_b32 v11, v13
    v_mov_b32 v12, v14
    v_mov_b32 v13, v15
    v_mov_b32 v14, v44
    v_mov_b32 v15, v45
    s_add_u32 s49, s49, 1
    s_cmp_eq_u32 s49, 3
    s_cselect_b32 s36, s44, s36
    s_cselect_b32 s37, s45, s37
    s_cmp_lt_u32 s49, 4
    s_cbranch_scc1 L_kloop
    v_max3_f32 v32, v8, v9, v10
    v_max3_f32 v32, v32, v11, v12
    v_max3_f32 v32, v32, v13, v14
    v_max_f32 v32, v32, v15
    s_nop 1
    v_max_f32_dpp v32, v32, v32 row_ror:8 row_mask:0xf bank_mask:0xf
    s_nop 1
    v_max_f32_dpp v32, v32, v32 row_ror:4 row_mask:0xf bank_mask:0xf
    s_nop 1
    v_max_f32_dpp v32, v32, v32 row_ror:2 row_mask:0xf bank_mask:0xf
    s_nop 1
    v_max_f32_dpp v32, v32, v32 row_ror:1 row_mask:0xf bank_mask:0xf
    s_nop 0
    v_readlane_b32 s54, v32, 0
    v_readlane_b32 s55, v32, 16
    v_readlane_b32 s56, v32, 32
    v_readlane_b32 s58, v32, 48
    v_mov_b32 v32, s54
    v_max_f32 v32, s55, v32
    v_max_f32 v32, s56, v32
    v_max_f32 v32, s58, v32
    v_mov_b32 v33, 0x3e0293ee
    v_mul_f32 v32, v33, v32
    v_fma_f32 v8, v8, v33, -v32
    v_fma_f32 v9, v9, v33, -v32
    v_fma_f32 v10, v10, v33, -v32
    v_fma_f32 v11, v11, v33, -v32
    v_fma_f32 v12, v12, v33, -v32
    v_fma_f32 v13, v13, v33, -v32
    v_fma_f32 v14, v14, v33, -v32
    v_fma_f32 v15, v15, v33, -v32
    v_exp_f32 v8, v8
    v_exp_f32 v9, v9
    v_exp_f32 v10, v10
    v_exp_f32 v11, v11
    v_exp_f32 v12, v12
    v_exp_f32 v13, v13
    v_exp_f32 v14, v14
    v_exp_f32 v15, v15
    v_add_f32 v34, v8, v9
    v_add_f32 v35, v10, v11
    v_add_f32 v36, v12, v13
    v_add_f32 v37, v14, v15
    v_add_f32 v34, v34, v35
    v_add_f32 v36, v36, v37
    v_add_f32 v34, v34, v36
    s_nop 1
    v_add_f32_dpp v34, v34, v34 row_ror:8 row_mask:0xf bank_mask:0xf
    s_nop 1
    v_add_f32_dpp v34, v34, v34 row_ror:4 row_mask:0xf bank_mask:0xf
    s_nop 1
    v_add_f32_dpp v34, v34, v34 row_ror:2 row_mask:0xf bank_mask:0xf
    s_nop 1
    v_add_f32_dpp v34, v34, v34 row_ror:1 row_mask:0xf bank_mask:0xf
    s_nop 0
    v_readlane_b32 s54, v34, 0
    v_readlane_b32 s55, v34, 16
    v_readlane_b32 s56, v34, 32
    v_readlane_b32 s58, v34, 48
    v_mov_b32 v34, s54
    v_add_f32 v34, s55, v34
    v_add_f32 v34, s56, v34
    v_add_f32 v34, s58, v34
    v_cvt_pk_bf16_f32 v8, v8, v8
    v_cvt_pk_bf16_f32 v9, v9, v9
    v_cvt_pk_bf16_f32 v10, v10, v10
    v_cvt_pk_bf16_f32 v11, v11, v11
    v_cvt_pk_bf16_f32 v12, v12, v12
    v_cvt_pk_bf16_f32 v13, v13, v13
    v_cvt_pk_bf16_f32 v14, v14, v14
    v_cvt_pk_bf16_f32 v15, v15, v15
    v_min_u32 v36, 0xfffffffe, v32
    v_min_u32 v37, 0xfffffffe, v34
    buffer_store_dwordx2 v[36:37], v47, s[40:43], 0 offen sc1
    v_mov_b32 v28, 0
    v_mov_b32 v29, 0
    v_mov_b32 v30, 0
    v_mov_b32 v31, 0
    s_lshl_b32 s58, s57, 9
    v_lshlrev_b32 v46, 5, v3
    v_lshl_add_u32 v46, v2, 4, v46
    v_add_u32 v46, s58, v46
    v_and_b32 v48, 31, v1
    v_mul_u32_u24 v48, 8, v48
    v_mov_b32 v49, 0x80000
    s_lshl_b32 s58, s33, 11
    s_add_u32 s58, s58, 1679360
    v_lshl_add_u32 v51, v3, 7, s58
    s_mov_b32 s49, 0
L_vloop:
    s_waitcnt vmcnt(31)
    v_and_b32_dpp v20, v8, v16 row_newbcast:0 row_mask:0xf bank_mask:0xf
    v_and_b32_dpp v21, v8, v17 row_newbcast:0 row_mask:0xf bank_mask:0xf
    v_and_b32_dpp v22, v8, v18 row_newbcast:0 row_mask:0xf bank_mask:0xf
    v_and_b32_dpp v23, v8, v19 row_newbcast:0 row_mask:0xf bank_mask:0xf
    s_nop 1
    v_mfma_f32_16x16x32_bf16 v[28:31], v[20:23], v[128:131], v[28:31]
    s_waitcnt vmcnt(6)
    buffer_load_dwordx4 v[128:131], v4, s[36:39], s48 offen offset:0 nt
    s_waitcnt vmcnt(31)
    v_and_b32_dpp v24, v8, v16 row_newbcast:8 row_mask:0xf bank_mask:0xf
    v_and_b32_dpp v25, v8, v17 row_newbcast:8 row_mask:0xf bank_mask:0xf
    v_and_b32_dpp v26, v8, v18 row_newbcast:8 row_mask:0xf bank_mask:0xf
    v_and_b32_dpp v27, v8, v19 row_newbcast:8 row_mask:0xf bank_mask:0xf
    s_nop 1
    v_mfma_f32_16x16x32_bf16 v[28:31], v[24:27], v[132:135], v[28:31]
    s_waitcnt vmcnt(6)
    buffer_load_dwordx4 v[132:135], v4, s[36:39], s48 offen offset:1024 nt
    s_waitcnt vmcnt(31)
    v_and_b32_dpp v20, v8, v16 row_newbcast:4 row_mask:0xf bank_mask:0xf
    v_and_b32_dpp v21, v8, v17 row_newbcast:4 row_mask:0xf bank_mask:0xf
    v_and_b32_dpp v22, v8, v18 row_newbcast:4 row_mask:0xf bank_mask:0xf
    v_and_b32_dpp v23, v8, v19 row_newbcast:4 row_mask:0xf bank_mask:0xf
    s_nop 1
    v_mfma_f32_16x16x32_bf16 v[28:31], v[20:23], v[136:139], v[28:31]
    s_waitcnt vmcnt(6)
    buffer_load_dwordx4 v[136:139], v4, s[36:39], s48 offen offset:2048 nt
    s_waitcnt vmcnt(31)
    v_and_b32_dpp v24, v8, v16 row_newbcast:12 row_mask:0xf bank_mask:0xf
    v_and_b32_dpp v25, v8, v17 row_newbcast:12 row_mask:0xf bank_mask:0xf
    v_and_b32_dpp v26, v8, v18 row_newbcast:12 row_mask:0xf bank_mask:0xf
    v_and_b32_dpp v27, v8, v19 row_newbcast:12 row_mask:0xf bank_mask:0xf
    s_nop 1
    v_mfma_f32_16x16x32_bf16 v[28:31], v[24:27], v[140:143], v[28:31]
    s_waitcnt vmcnt(6)
    buffer_load_dwordx4 v[140:143], v4, s[36:39], s48 offen offset:3072 nt
    s_add_u32 s48, s48, 0x4000
    s_and_b32 s48, s48, 0x7ffff
    s_waitcnt vmcnt(31)
    v_and_b32_dpp v20, v8, v16 row_newbcast:2 row_mask:0xf bank_mask:0xf
    v_and_b32_dpp v21, v8, v17 row_newbcast:2 row_mask:0xf bank_mask:0xf
    v_and_b32_dpp v22, v8, v18 row_newbcast:2 row_mask:0xf bank_mask:0xf
    v_and_b32_dpp v23, v8, v19 row_newbcast:2 row_mask:0xf bank_mask:0xf
    s_nop 1
    v_mfma_f32_16x16x32_bf16 v[28:31], v[20:23], v[144:147], v[28:31]
    s_waitcnt vmcnt(6)
    buffer_load_dwordx4 v[144:147], v4, s[36:39], s48 offen offset:0 nt
    s_waitcnt vmcnt(31)
    v_and_b32_dpp v24, v8, v16 row_newbcast:10 row_mask:0xf bank_mask:0xf
    v_and_b32_dpp v25, v8, v17 row_newbcast:10 row_mask:0xf bank_mask:0xf
    v_and_b32_dpp v26, v8, v18 row_newbcast:10 row_mask:0xf bank_mask:0xf
    v_and_b32_dpp v27, v8, v19 row_newbcast:10 row_mask:0xf bank_mask:0xf
    s_nop 1
    v_mfma_f32_16x16x32_bf16 v[28:31], v[24:27], v[148:151], v[28:31]
    s_waitcnt vmcnt(6)
    buffer_load_dwordx4 v[148:151], v4, s[36:39], s48 offen offset:1024 nt
    s_waitcnt vmcnt(31)
    v_and_b32_dpp v20, v8, v16 row_newbcast:6 row_mask:0xf bank_mask:0xf
    v_and_b32_dpp v21, v8, v17 row_newbcast:6 row_mask:0xf bank_mask:0xf
    v_and_b32_dpp v22, v8, v18 row_newbcast:6 row_mask:0xf bank_mask:0xf
    v_and_b32_dpp v23, v8, v19 row_newbcast:6 row_mask:0xf bank_mask:0xf
    s_nop 1
    v_mfma_f32_16x16x32_bf16 v[28:31], v[20:23], v[152:155], v[28:31]
    s_waitcnt vmcnt(6)
    buffer_load_dwordx4 v[152:155], v4, s[36:39], s48 offen offset:2048 nt
    s_waitcnt vmcnt(31)
    v_and_b32_dpp v24, v8, v16 row_newbcast:14 row_mask:0xf bank_mask:0xf
    v_and_b32_dpp v25, v8, v17 row_newbcast:14 row_mask:0xf bank_mask:0xf
    v_and_b32_dpp v26, v8, v18 row_newbcast:14 row_mask:0xf bank_mask:0xf
    v_and_b32_dpp v27, v8, v19 row_newbcast:14 row_mask:0xf bank_mask:0xf
    s_nop 1
    v_mfma_f32_16x16x32_bf16 v[28:31], v[24:27], v[156:159], v[28:31]
    s_waitcnt vmcnt(6)
    buffer_load_dwordx4 v[156:159], v4, s[36:39], s48 offen offset:3072 nt
    s_add_u32 s48, s48, 0x4000
    s_and_b32 s48, s48, 0x7ffff
    s_waitcnt vmcnt(31)
    v_and_b32_dpp v20, v8, v16 row_newbcast:1 row_mask:0xf bank_mask:0xf
    v_and_b32_dpp v21, v8, v17 row_newbcast:1 row_mask:0xf bank_mask:0xf
    v_and_b32_dpp v22, v8, v18 row_newbcast:1 row_mask:0xf bank_mask:0xf
    v_and_b32_dpp v23, v8, v19 row_newbcast:1 row_mask:0xf bank_mask:0xf
    s_nop 1
    v_mfma_f32_16x16x32_bf16 v[28:31], v[20:23], v[160:163], v[28:31]
    s_waitcnt vmcnt(6)
    buffer_load_dwordx4 v[160:163], v4, s[36:39], s48 offen offset:0 nt
    s_waitcnt vmcnt(31)
    v_and_b32_dpp v24, v8, v16 row_newbcast:9 row_mask:0xf bank_mask:0xf
    v_and_b32_dpp v25, v8, v17 row_newbcast:9 row_mask:0xf bank_mask:0xf
    v_and_b32_dpp v26, v8, v18 row_newbcast:9 row_mask:0xf bank_mask:0xf
    v_and_b32_dpp v27, v8, v19 row_newbcast:9 row_mask:0xf bank_mask:0xf
    s_nop 1
    v_mfma_f32_16x16x32_bf16 v[28:31], v[24:27], v[164:167], v[28:31]
    s_waitcnt vmcnt(6)
    buffer_load_dwordx4 v[164:167], v4, s[36:39], s48 offen offset:1024 nt
    s_waitcnt vmcnt(31)
    v_and_b32_dpp v20, v8, v16 row_newbcast:5 row_mask:0xf bank_mask:0xf
    v_and_b32_dpp v21, v8, v17 row_newbcast:5 row_mask:0xf bank_mask:0xf
    v_and_b32_dpp v22, v8, v18 row_newbcast:5 row_mask:0xf bank_mask:0xf
    v_and_b32_dpp v23, v8, v19 row_newbcast:5 row_mask:0xf bank_mask:0xf
    s_nop 1
    v_mfma_f32_16x16x32_bf16 v[28:31], v[20:23], v[168:171], v[28:31]
    s_waitcnt vmcnt(6)
    buffer_load_dwordx4 v[168:171], v4, s[36:39], s48 offen offset:2048 nt
    s_waitcnt vmcnt(31)
    v_and_b32_dpp v24, v8, v16 row_newbcast:13 row_mask:0xf bank_mask:0xf
    v_and_b32_dpp v25, v8, v17 row_newbcast:13 row_mask:0xf bank_mask:0xf
    v_and_b32_dpp v26, v8, v18 row_newbcast:13 row_mask:0xf bank_mask:0xf
    v_and_b32_dpp v27, v8, v19 row_newbcast:13 row_mask:0xf bank_mask:0xf
    s_nop 1
    v_mfma_f32_16x16x32_bf16 v[28:31], v[24:27], v[172:175], v[28:31]
    s_waitcnt vmcnt(6)
    buffer_load_dwordx4 v[172:175], v4, s[36:39], s48 offen offset:3072 nt
    s_add_u32 s48, s48, 0x4000
    s_and_b32 s48, s48, 0x7ffff
    s_waitcnt vmcnt(31)
    v_and_b32_dpp v20, v8, v16 row_newbcast:3 row_mask:0xf bank_mask:0xf
    v_and_b32_dpp v21, v8, v17 row_newbcast:3 row_mask:0xf bank_mask:0xf
    v_and_b32_dpp v22, v8, v18 row_newbcast:3 row_mask:0xf bank_mask:0xf
    v_and_b32_dpp v23, v8, v19 row_newbcast:3 row_mask:0xf bank_mask:0xf
    s_nop 1
    v_mfma_f32_16x16x32_bf16 v[28:31], v[20:23], v[176:179], v[28:31]
    s_waitcnt vmcnt(6)
    buffer_load_dwordx4 v[176:179], v4, s[36:39], s48 offen offset:0 nt
    s_waitcnt vmcnt(31)
    v_and_b32_dpp v24, v8, v16 row_newbcast:11 row_mask:0xf bank_mask:0xf
    v_and_b32_dpp v25, v8, v17 row_newbcast:11 row_mask:0xf bank_mask:0xf
    v_and_b32_dpp v26, v8, v18 row_newbcast:11 row_mask:0xf bank_mask:0xf
    v_and_b32_dpp v27, v8, v19 row_newbcast:11 row_mask:0xf bank_mask:0xf
    s_nop 1
    v_mfma_f32_16x16x32_bf16 v[28:31], v[24:27], v[180:183], v[28:31]
    s_waitcnt vmcnt(6)
    buffer_load_dwordx4 v[180:183], v4, s[36:39], s48 offen offset:1024 nt
    s_waitcnt vmcnt(31)
    v_and_b32_dpp v20, v8, v16 row_newbcast:7 row_mask:0xf bank_mask:0xf
    v_and_b32_dpp v21, v8, v17 row_newbcast:7 row_mask:0xf bank_mask:0xf
    v_and_b32_dpp v22, v8, v18 row_newbcast:7 row_mask:0xf bank_mask:0xf
    v_and_b32_dpp v23, v8, v19 row_newbcast:7 row_mask:0xf bank_mask:0xf
    s_nop 1
    v_mfma_f32_16x16x32_bf16 v[28:31], v[20:23], v[184:187], v[28:31]
    s_waitcnt vmcnt(6)
    buffer_load_dwordx4 v[184:187], v4, s[36:39], s48 offen offset:2048 nt
    s_waitcnt vmcnt(31)
    v_and_b32_dpp v24, v8, v16 row_newbcast:15 row_mask:0xf bank_mask:0xf
    v_and_b32_dpp v25, v8, v17 row_newbcast:15 row_mask:0xf bank_mask:0xf
    v_and_b32_dpp v26, v8, v18 row_newbcast:15 row_mask:0xf bank_mask:0xf
    v_and_b32_dpp v27, v8, v19 row_newbcast:15 row_mask:0xf bank_mask:0xf
    s_nop 1
    v_mfma_f32_16x16x32_bf16 v[28:31], v[24:27], v[188:191], v[28:31]
    s_waitcnt vmcnt(6)
    buffer_load_dwordx4 v[188:191], v4, s[36:39], s48 offen offset:3072 nt
    s_add_u32 s48, s48, 0x4000
    s_and_b32 s48, s48, 0x7ffff
    s_waitcnt vmcnt(31)
    v_and_b32_dpp v20, v9, v16 row_newbcast:0 row_mask:0xf bank_mask:0xf
    v_and_b32_dpp v21, v9, v17 row_newbcast:0 row_mask:0xf bank_mask:0xf
    v_and_b32_dpp v22, v9, v18 row_newbcast:0 row_mask:0xf bank_mask:0xf
    v_and_b32_dpp v23, v9, v19 row_newbcast:0 row_mask:0xf bank_mask:0xf
    s_nop 1
    v_mfma_f32_16x16x32_bf16 v[28:31], v[20:23], v[192:195], v[28:31]
    s_waitcnt vmcnt(6)
    buffer_load_dwordx4 v[192:195], v4, s[36:39], s48 offen offset:0 nt
    s_waitcnt vmcnt(31)
    v_and_b32_dpp v24, v9, v16 row_newbcast:8 row_mask:0xf bank_mask:0xf
    v_and_b32_dpp v25, v9, v17 row_newbcast:8 row_mask:0xf bank_mask:0xf
    v_and_b32_dpp v26, v9, v18 row_newbcast:8 row_mask:0xf bank_mask:0xf
    v_and_b32_dpp v27, v9, v19 row_newbcast:8 row_mask:0xf bank_mask:0xf
    s_nop 1
    v_mfma_f32_16x16x32_bf16 v[28:31], v[24:27], v[196:199], v[28:31]
    s_waitcnt vmcnt(6)
    buffer_load_dwordx4 v[196:199], v4, s[36:39], s48 offen offset:1024 nt
    s_waitcnt vmcnt(31)
    v_and_b32_dpp v20, v9, v16 row_newbcast:4 row_mask:0xf bank_mask:0xf
    v_and_b32_dpp v21, v9, v17 row_newbcast:4 row_mask:0xf bank_mask:0xf
    v_and_b32_dpp v22, v9, v18 row_newbcast:4 row_mask:0xf bank_mask:0xf
    v_and_b32_dpp v23, v9, v19 row_newbcast:4 row_mask:0xf bank_mask:0xf
    s_nop 1
    v_mfma_f32_16x16x32_bf16 v[28:31], v[20:23], v[200:203], v[28:31]
    s_waitcnt vmcnt(6)
    buffer_load_dwordx4 v[200:203], v4, s[36:39], s48 offen offset:2048 nt
    s_waitcnt vmcnt(31)
    v_and_b32_dpp v24, v9, v16 row_newbcast:12 row_mask:0xf bank_mask:0xf
    v_and_b32_dpp v25, v9, v17 row_newbcast:12 row_mask:0xf bank_mask:0xf
    v_and_b32_dpp v26, v9, v18 row_newbcast:12 row_mask:0xf bank_mask:0xf
    v_and_b32_dpp v27, v9, v19 row_newbcast:12 row_mask:0xf bank_mask:0xf
    s_nop 1
    v_mfma_f32_16x16x32_bf16 v[28:31], v[24:27], v[204:207], v[28:31]
    s_waitcnt vmcnt(6)
    buffer_load_dwordx4 v[204:207], v4, s[36:39], s48 offen offset:3072 nt
    s_add_u32 s48, s48, 0x4000
    s_and_b32 s48, s48, 0x7ffff
    s_waitcnt vmcnt(31)
    v_and_b32_dpp v20, v9, v16 row_newbcast:2 row_mask:0xf bank_mask:0xf
    v_and_b32_dpp v21, v9, v17 row_newbcast:2 row_mask:0xf bank_mask:0xf
    v_and_b32_dpp v22, v9, v18 row_newbcast:2 row_mask:0xf bank_mask:0xf
    v_and_b32_dpp v23, v9, v19 row_newbcast:2 row_mask:0xf bank_mask:0xf
    s_nop 1
    v_mfma_f32_16x16x32_bf16 v[28:31], v[20:23], v[208:211], v[28:31]
    s_waitcnt vmcnt(6)
    buffer_load_dwordx4 v[208:211], v4, s[36:39], s48 offen offset:0 nt
    s_waitcnt vmcnt(31)
    v_and_b32_dpp v24, v9, v16 row_newbcast:10 row_mask:0xf bank_mask:0xf
    v_and_b32_dpp v25, v9, v17 row_newbcast:10 row_mask:0xf bank_mask:0xf
    v_and_b32_dpp v26, v9, v18 row_newbcast:10 row_mask:0xf bank_mask:0xf
    v_and_b32_dpp v27, v9, v19 row_newbcast:10 row_mask:0xf bank_mask:0xf
    s_nop 1
    v_mfma_f32_16x16x32_bf16 v[28:31], v[24:27], v[212:215], v[28:31]
    s_waitcnt vmcnt(6)
    buffer_load_dwordx4 v[212:215], v4, s[36:39], s48 offen offset:1024 nt
    s_waitcnt vmcnt(31)
    v_and_b32_dpp v20, v9, v16 row_newbcast:6 row_mask:0xf bank_mask:0xf
    v_and_b32_dpp v21, v9, v17 row_newbcast:6 row_mask:0xf bank_mask:0xf
    v_and_b32_dpp v22, v9, v18 row_newbcast:6 row_mask:0xf bank_mask:0xf
    v_and_b32_dpp v23, v9, v19 row_newbcast:6 row_mask:0xf bank_mask:0xf
    s_nop 1
    v_mfma_f32_16x16x32_bf16 v[28:31], v[20:23], v[216:219], v[28:31]
    s_waitcnt vmcnt(6)
    buffer_load_dwordx4 v[216:219], v4, s[36:39], s48 offen offset:2048 nt
    s_waitcnt vmcnt(31)
    v_and_b32_dpp v24, v9, v16 row_newbcast:14 row_mask:0xf bank_mask:0xf
    v_and_b32_dpp v25, v9, v17 row_newbcast:14 row_mask:0xf bank_mask:0xf
    v_and_b32_dpp v26, v9, v18 row_newbcast:14 row_mask:0xf bank_mask:0xf
    v_and_b32_dpp v27, v9, v19 row_newbcast:14 row_mask:0xf bank_mask:0xf
    s_nop 1
    v_mfma_f32_16x16x32_bf16 v[28:31], v[24:27], v[220:223], v[28:31]
    s_waitcnt vmcnt(6)
    buffer_load_dwordx4 v[220:223], v4, s[36:39], s48 offen offset:3072 nt
    s_add_u32 s48, s48, 0x4000
    s_and_b32 s48, s48, 0x7ffff
    s_waitcnt vmcnt(31)
    v_and_b32_dpp v20, v9, v16 row_newbcast:1 row_mask:0xf bank_mask:0xf
    v_and_b32_dpp v21, v9, v17 row_newbcast:1 row_mask:0xf bank_mask:0xf
    v_and_b32_dpp v22, v9, v18 row_newbcast:1 row_mask:0xf bank_mask:0xf
    v_and_b32_dpp v23, v9, v19 row_newbcast:1 row_mask:0xf bank_mask:0xf
    s_nop 1
    v_mfma_f32_16x16x32_bf16 v[28:31], v[20:23], v[224:227], v[28:31]
    s_waitcnt vmcnt(6)
    buffer_load_dwordx4 v[224:227], v4, s[36:39], s48 offen offset:0 nt
    s_waitcnt vmcnt(31)
    v_and_b32_dpp v24, v9, v16 row_newbcast:9 row_mask:0xf bank_mask:0xf
    v_and_b32_dpp v25, v9, v17 row_newbcast:9 row_mask:0xf bank_mask:0xf
    v_and_b32_dpp v26, v9, v18 row_newbcast:9 row_mask:0xf bank_mask:0xf
    v_and_b32_dpp v27, v9, v19 row_newbcast:9 row_mask:0xf bank_mask:0xf
    s_nop 1
    v_mfma_f32_16x16x32_bf16 v[28:31], v[24:27], v[228:231], v[28:31]
    s_waitcnt vmcnt(6)
    buffer_load_dwordx4 v[228:231], v4, s[36:39], s48 offen offset:1024 nt
    s_waitcnt vmcnt(31)
    v_and_b32_dpp v20, v9, v16 row_newbcast:5 row_mask:0xf bank_mask:0xf
    v_and_b32_dpp v21, v9, v17 row_newbcast:5 row_mask:0xf bank_mask:0xf
    v_and_b32_dpp v22, v9, v18 row_newbcast:5 row_mask:0xf bank_mask:0xf
    v_and_b32_dpp v23, v9, v19 row_newbcast:5 row_mask:0xf bank_mask:0xf
    s_nop 1
    v_mfma_f32_16x16x32_bf16 v[28:31], v[20:23], v[232:235], v[28:31]
    s_waitcnt vmcnt(6)
    buffer_load_dwordx4 v[232:235], v4, s[36:39], s48 offen offset:2048 nt
    s_waitcnt vmcnt(31)
    v_and_b32_dpp v24, v9, v16 row_newbcast:13 row_mask:0xf bank_mask:0xf
    v_and_b32_dpp v25, v9, v17 row_newbcast:13 row_mask:0xf bank_mask:0xf
    v_and_b32_dpp v26, v9, v18 row_newbcast:13 row_mask:0xf bank_mask:0xf
    v_and_b32_dpp v27, v9, v19 row_newbcast:13 row_mask:0xf bank_mask:0xf
    s_nop 1
    v_mfma_f32_16x16x32_bf16 v[28:31], v[24:27], v[236:239], v[28:31]
    s_waitcnt vmcnt(6)
    buffer_load_dwordx4 v[236:239], v4, s[36:39], s48 offen offset:3072 nt
    s_add_u32 s48, s48, 0x4000
    s_and_b32 s48, s48, 0x7ffff
    s_waitcnt vmcnt(31)
    v_and_b32_dpp v20, v9, v16 row_newbcast:3 row_mask:0xf bank_mask:0xf
    v_and_b32_dpp v21, v9, v17 row_newbcast:3 row_mask:0xf bank_mask:0xf
    v_and_b32_dpp v22, v9, v18 row_newbcast:3 row_mask:0xf bank_mask:0xf
    v_and_b32_dpp v23, v9, v19 row_newbcast:3 row_mask:0xf bank_mask:0xf
    s_nop 1
    v_mfma_f32_16x16x32_bf16 v[28:31], v[20:23], v[240:243], v[28:31]
    s_waitcnt vmcnt(6)
    buffer_load_dwordx4 v[240:243], v4, s[36:39], s48 offen offset:0 nt
    s_waitcnt vmcnt(31)
    v_and_b32_dpp v24, v9, v16 row_newbcast:11 row_mask:0xf bank_mask:0xf
    v_and_b32_dpp v25, v9, v17 row_newbcast:11 row_mask:0xf bank_mask:0xf
    v_and_b32_dpp v26, v9, v18 row_newbcast:11 row_mask:0xf bank_mask:0xf
    v_and_b32_dpp v27, v9, v19 row_newbcast:11 row_mask:0xf bank_mask:0xf
    s_nop 1
    v_mfma_f32_16x16x32_bf16 v[28:31], v[24:27], v[244:247], v[28:31]
    s_waitcnt vmcnt(6)
    buffer_load_dwordx4 v[244:247], v4, s[36:39], s48 offen offset:1024 nt
    s_waitcnt vmcnt(31)
    v_and_b32_dpp v20, v9, v16 row_newbcast:7 row_mask:0xf bank_mask:0xf
    v_and_b32_dpp v21, v9, v17 row_newbcast:7 row_mask:0xf bank_mask:0xf
    v_and_b32_dpp v22, v9, v18 row_newbcast:7 row_mask:0xf bank_mask:0xf
    v_and_b32_dpp v23, v9, v19 row_newbcast:7 row_mask:0xf bank_mask:0xf
    s_nop 1
    v_mfma_f32_16x16x32_bf16 v[28:31], v[20:23], v[248:251], v[28:31]
    s_waitcnt vmcnt(6)
    buffer_load_dwordx4 v[248:251], v4, s[36:39], s48 offen offset:2048 nt
    s_waitcnt vmcnt(31)
    v_and_b32_dpp v24, v9, v16 row_newbcast:15 row_mask:0xf bank_mask:0xf
    v_and_b32_dpp v25, v9, v17 row_newbcast:15 row_mask:0xf bank_mask:0xf
    v_and_b32_dpp v26, v9, v18 row_newbcast:15 row_mask:0xf bank_mask:0xf
    v_and_b32_dpp v27, v9, v19 row_newbcast:15 row_mask:0xf bank_mask:0xf
    s_nop 1
    v_mfma_f32_16x16x32_bf16 v[28:31], v[24:27], v[252:255], v[28:31]
    s_waitcnt vmcnt(6)
    buffer_load_dwordx4 v[252:255], v4, s[36:39], s48 offen offset:3072 nt
    s_add_u32 s48, s48, 0x4000
    s_and_b32 s48, s48, 0x7ffff
    v_mov_b32 v8, v10
    v_mov_b32 v9, v11
    v_mov_b32 v10, v12
    v_mov_b32 v11, v13
    v_mov_b32 v12, v14
    v_mov_b32 v13, v15
    s_cmp_eq_u32 s49, 1
    s_cbranch_scc0 L_v_n2
    s_mov_b32 s59, 0
    v_mov_b32 v50, 0
L_v_fl:
    ds_read_b32 v49, v50 offset:1040
    s_add_u32 s59, s59, 1
    s_waitcnt lgkmcnt(0)
    v_readfirstlane_b32 s58, v49
    s_cmp_ge_u32 s59, 1048576
    s_cbranch_scc1 L_v_fl_done
    s_cmp_lg_u32 s58, 0
    s_cbranch_scc1 L_v_fl_done
    s_sleep 4
    s_branch L_v_fl
L_v_fl_done:
    buffer_load_dwordx2 v[52:53], v51, s[40:43], 0 offen sc1
L_v_n2:
    s_add_u32 s49, s49, 1
    s_cmp_lt_u32 s49, 3
    s_cbranch_scc1 L_vloop
    s_mov_b32 s59, 0
    s_waitcnt vmcnt(32)
L_v_ml:
    v_max_u32 v54, v52, v53
    v_cmp_eq_u32 vcc, -1, v54
    s_add_u32 s59, s59, 1
    s_cmp_ge_u32 s59, 65536
    s_cbranch_scc1 L_v_ml_done
    s_cbranch_vccz L_v_ml_done
    s_sleep 8
    buffer_load_dwordx2 v[52:53], v51, s[40:43], 0 offen sc1
    s_waitcnt vmcnt(0)
    s_branch L_v_ml
L_v_ml_done:
    v_mov_b32 v54, v52
    s_nop 1
    v_max_f32_dpp v54, v54, v54 row_ror:8 row_mask:0xf bank_mask:0xf
    s_nop 1
    v_max_f32_dpp v54, v54, v54 row_ror:4 row_mask:0xf bank_mask:0xf
    s_nop 1
    v_max_f32_dpp v54, v54, v54 row_ror:2 row_mask:0xf bank_mask:0xf
    s_nop 1
    v_max_f32_dpp v54, v54, v54 row_ror:1 row_mask:0xf bank_mask:0xf
    v_sub_f32 v52, v52, v54
    v_exp_f32 v52, v52
    s_nop 0
    v_mul_f32 v53, v52, v53
    s_nop 1
    v_add_f32_dpp v53, v53, v53 row_ror:8 row_mask:0xf bank_mask:0xf
    s_nop 1
    v_add_f32_dpp v53, v53, v53 row_ror:4 row_mask:0xf bank_mask:0xf
    s_nop 1
    v_add_f32_dpp v53, v53, v53 row_ror:2 row_mask:0xf bank_mask:0xf
    s_nop 1
    v_add_f32_dpp v53, v53, v53 row_ror:1 row_mask:0xf bank_mask:0xf
    v_rcp_f32 v53, v53
    s_lshl_b32 s59, s32, 2
    s_add_u32 s59, s59, s57
    v_mul_f32 v52, v52, v53
    v_mul_f32 v52, v52, v56
    s_nop 0
    v_readlane_b32 s68, v52, s59
    s_waitcnt vmcnt(31)
    v_and_b32_dpp v20, v8, v16 row_newbcast:0 row_mask:0xf bank_mask:0xf
    v_and_b32_dpp v21, v8, v17 row_newbcast:0 row_mask:0xf bank_mask:0xf
    v_and_b32_dpp v22, v8, v18 row_newbcast:0 row_mask:0xf bank_mask:0xf
    v_and_b32_dpp v23, v8, v19 row_newbcast:0 row_mask:0xf bank_mask:0xf
    s_nop 1
    v_mfma_f32_16x16x32_bf16 v[28:31], v[20:23], v[128:131], v[28:31]
    s_waitcnt vmcnt(30)
    v_and_b32_dpp v24, v8, v16 row_newbcast:8 row_mask:0xf bank_mask:0xf
    v_and_b32_dpp v25, v8, v17 row_newbcast:8 row_mask:0xf bank_mask:0xf
    v_and_b32_dpp v26, v8, v18 row_newbcast:8 row_mask:0xf bank_mask:0xf
    v_and_b32_dpp v27, v8, v19 row_newbcast:8 row_mask:0xf bank_mask:0xf
    s_nop 1
    v_mfma_f32_16x16x32_bf16 v[28:31], v[24:27], v[132:135], v[28:31]
    s_waitcnt vmcnt(29)
    v_and_b32_dpp v20, v8, v16 row_newbcast:4 row_mask:0xf bank_mask:0xf
    v_and_b32_dpp v21, v8, v17 row_newbcast:4 row_mask:0xf bank_mask:0xf
    v_and_b32_dpp v22, v8, v18 row_newbcast:4 row_mask:0xf bank_mask:0xf
    v_and_b32_dpp v23, v8, v19 row_newbcast:4 row_mask:0xf bank_mask:0xf
    s_nop 1
    v_mfma_f32_16x16x32_bf16 v[28:31], v[20:23], v[136:139], v[28:31]
    s_waitcnt vmcnt(28)
    v_and_b32_dpp v24, v8, v16 row_newbcast:12 row_mask:0xf bank_mask:0xf
    v_and_b32_dpp v25, v8, v17 row_newbcast:12 row_mask:0xf bank_mask:0xf
    v_and_b32_dpp v26, v8, v18 row_newbcast:12 row_mask:0xf bank_mask:0xf
    v_and_b32_dpp v27, v8, v19 row_newbcast:12 row_mask:0xf bank_mask:0xf
    s_nop 1
    v_mfma_f32_16x16x32_bf16 v[28:31], v[24:27], v[140:143], v[28:31]
    s_waitcnt vmcnt(27)
    v_and_b32_dpp v20, v8, v16 row_newbcast:2 row_mask:0xf bank_mask:0xf
    v_and_b32_dpp v21, v8, v17 row_newbcast:2 row_mask:0xf bank_mask:0xf
    v_and_b32_dpp v22, v8, v18 row_newbcast:2 row_mask:0xf bank_mask:0xf
    v_and_b32_dpp v23, v8, v19 row_newbcast:2 row_mask:0xf bank_mask:0xf
    s_nop 1
    v_mfma_f32_16x16x32_bf16 v[28:31], v[20:23], v[144:147], v[28:31]
    s_waitcnt vmcnt(26)
    v_and_b32_dpp v24, v8, v16 row_newbcast:10 row_mask:0xf bank_mask:0xf
    v_and_b32_dpp v25, v8, v17 row_newbcast:10 row_mask:0xf bank_mask:0xf
    v_and_b32_dpp v26, v8, v18 row_newbcast:10 row_mask:0xf bank_mask:0xf
    v_and_b32_dpp v27, v8, v19 row_newbcast:10 row_mask:0xf bank_mask:0xf
    s_nop 1
    v_mfma_f32_16x16x32_bf16 v[28:31], v[24:27], v[148:151], v[28:31]
    s_waitcnt vmcnt(25)
    v_and_b32_dpp v20, v8, v16 row_newbcast:6 row_mask:0xf bank_mask:0xf
    v_and_b32_dpp v21, v8, v17 row_newbcast:6 row_mask:0xf bank_mask:0xf
    v_and_b32_dpp v22, v8, v18 row_newbcast:6 row_mask:0xf bank_mask:0xf
    v_and_b32_dpp v23, v8, v19 row_newbcast:6 row_mask:0xf bank_mask:0xf
    s_nop 1
    v_mfma_f32_16x16x32_bf16 v[28:31], v[20:23], v[152:155], v[28:31]
    s_waitcnt vmcnt(24)
    v_and_b32_dpp v24, v8, v16 row_newbcast:14 row_mask:0xf bank_mask:0xf
    v_and_b32_dpp v25, v8, v17 row_newbcast:14 row_mask:0xf bank_mask:0xf
    v_and_b32_dpp v26, v8, v18 row_newbcast:14 row_mask:0xf bank_mask:0xf
    v_and_b32_dpp v27, v8, v19 row_newbcast:14 row_mask:0xf bank_mask:0xf
    s_nop 1
    v_mfma_f32_16x16x32_bf16 v[28:31], v[24:27], v[156:159], v[28:31]
    s_waitcnt vmcnt(23)
    v_and_b32_dpp v20, v8, v16 row_newbcast:1 row_mask:0xf bank_mask:0xf
    v_and_b32_dpp v21, v8, v17 row_newbcast:1 row_mask:0xf bank_mask:0xf
    v_and_b32_dpp v22, v8, v18 row_newbcast:1 row_mask:0xf bank_mask:0xf
    v_and_b32_dpp v23, v8, v19 row_newbcast:1 row_mask:0xf bank_mask:0xf
    s_nop 1
    v_mfma_f32_16x16x32_bf16 v[28:31], v[20:23], v[160:163], v[28:31]
    s_waitcnt vmcnt(22)
    v_and_b32_dpp v24, v8, v16 row_newbcast:9 row_mask:0xf bank_mask:0xf
    v_and_b32_dpp v25, v8, v17 row_newbcast:9 row_mask:0xf bank_mask:0xf
    v_and_b32_dpp v26, v8, v18 row_newbcast:9 row_mask:0xf bank_mask:0xf
    v_and_b32_dpp v27, v8, v19 row_newbcast:9 row_mask:0xf bank_mask:0xf
    s_nop 1
    v_mfma_f32_16x16x32_bf16 v[28:31], v[24:27], v[164:167], v[28:31]
    s_waitcnt vmcnt(21)
    v_and_b32_dpp v20, v8, v16 row_newbcast:5 row_mask:0xf bank_mask:0xf
    v_and_b32_dpp v21, v8, v17 row_newbcast:5 row_mask:0xf bank_mask:0xf
    v_and_b32_dpp v22, v8, v18 row_newbcast:5 row_mask:0xf bank_mask:0xf
    v_and_b32_dpp v23, v8, v19 row_newbcast:5 row_mask:0xf bank_mask:0xf
    s_nop 1
    v_mfma_f32_16x16x32_bf16 v[28:31], v[20:23], v[168:171], v[28:31]
    s_waitcnt vmcnt(20)
    v_and_b32_dpp v24, v8, v16 row_newbcast:13 row_mask:0xf bank_mask:0xf
    v_and_b32_dpp v25, v8, v17 row_newbcast:13 row_mask:0xf bank_mask:0xf
    v_and_b32_dpp v26, v8, v18 row_newbcast:13 row_mask:0xf bank_mask:0xf
    v_and_b32_dpp v27, v8, v19 row_newbcast:13 row_mask:0xf bank_mask:0xf
    s_nop 1
    v_mfma_f32_16x16x32_bf16 v[28:31], v[24:27], v[172:175], v[28:31]
    s_waitcnt vmcnt(19)
    v_and_b32_dpp v20, v8, v16 row_newbcast:3 row_mask:0xf bank_mask:0xf
    v_and_b32_dpp v21, v8, v17 row_newbcast:3 row_mask:0xf bank_mask:0xf
    v_and_b32_dpp v22, v8, v18 row_newbcast:3 row_mask:0xf bank_mask:0xf
    v_and_b32_dpp v23, v8, v19 row_newbcast:3 row_mask:0xf bank_mask:0xf
    s_nop 1
    v_mfma_f32_16x16x32_bf16 v[28:31], v[20:23], v[176:179], v[28:31]
    s_waitcnt vmcnt(18)
    v_and_b32_dpp v24, v8, v16 row_newbcast:11 row_mask:0xf bank_mask:0xf
    v_and_b32_dpp v25, v8, v17 row_newbcast:11 row_mask:0xf bank_mask:0xf
    v_and_b32_dpp v26, v8, v18 row_newbcast:11 row_mask:0xf bank_mask:0xf
    v_and_b32_dpp v27, v8, v19 row_newbcast:11 row_mask:0xf bank_mask:0xf
    s_nop 1
    v_mfma_f32_16x16x32_bf16 v[28:31], v[24:27], v[180:183], v[28:31]
    s_waitcnt vmcnt(17)
    v_and_b32_dpp v20, v8, v16 row_newbcast:7 row_mask:0xf bank_mask:0xf
    v_and_b32_dpp v21, v8, v17 row_newbcast:7 row_mask:0xf bank_mask:0xf
    v_and_b32_dpp v22, v8, v18 row_newbcast:7 row_mask:0xf bank_mask:0xf
    v_and_b32_dpp v23, v8, v19 row_newbcast:7 row_mask:0xf bank_mask:0xf
    s_nop 1
    v_mfma_f32_16x16x32_bf16 v[28:31], v[20:23], v[184:187], v[28:31]
    s_waitcnt vmcnt(16)
    v_and_b32_dpp v24, v8, v16 row_newbcast:15 row_mask:0xf bank_mask:0xf
    v_and_b32_dpp v25, v8, v17 row_newbcast:15 row_mask:0xf bank_mask:0xf
    v_and_b32_dpp v26, v8, v18 row_newbcast:15 row_mask:0xf bank_mask:0xf
    v_and_b32_dpp v27, v8, v19 row_newbcast:15 row_mask:0xf bank_mask:0xf
    s_nop 1
    v_mfma_f32_16x16x32_bf16 v[28:31], v[24:27], v[188:191], v[28:31]
    s_waitcnt vmcnt(15)
    v_and_b32_dpp v20, v9, v16 row_newbcast:0 row_mask:0xf bank_mask:0xf
    v_and_b32_dpp v21, v9, v17 row_newbcast:0 row_mask:0xf bank_mask:0xf
    v_and_b32_dpp v22, v9, v18 row_newbcast:0 row_mask:0xf bank_mask:0xf
    v_and_b32_dpp v23, v9, v19 row_newbcast:0 row_mask:0xf bank_mask:0xf
    s_nop 1
    v_mfma_f32_16x16x32_bf16 v[28:31], v[20:23], v[192:195], v[28:31]
    s_waitcnt vmcnt(14)
    v_and_b32_dpp v24, v9, v16 row_newbcast:8 row_mask:0xf bank_mask:0xf
    v_and_b32_dpp v25, v9, v17 row_newbcast:8 row_mask:0xf bank_mask:0xf
    v_and_b32_dpp v26, v9, v18 row_newbcast:8 row_mask:0xf bank_mask:0xf
    v_and_b32_dpp v27, v9, v19 row_newbcast:8 row_mask:0xf bank_mask:0xf
    s_nop 1
    v_mfma_f32_16x16x32_bf16 v[28:31], v[24:27], v[196:199], v[28:31]
    s_waitcnt vmcnt(13)
    v_and_b32_dpp v20, v9, v16 row_newbcast:4 row_mask:0xf bank_mask:0xf
    v_and_b32_dpp v21, v9, v17 row_newbcast:4 row_mask:0xf bank_mask:0xf
    v_and_b32_dpp v22, v9, v18 row_newbcast:4 row_mask:0xf bank_mask:0xf
    v_and_b32_dpp v23, v9, v19 row_newbcast:4 row_mask:0xf bank_mask:0xf
    s_nop 1
    v_mfma_f32_16x16x32_bf16 v[28:31], v[20:23], v[200:203], v[28:31]
    s_waitcnt vmcnt(12)
    v_and_b32_dpp v24, v9, v16 row_newbcast:12 row_mask:0xf bank_mask:0xf
    v_and_b32_dpp v25, v9, v17 row_newbcast:12 row_mask:0xf bank_mask:0xf
    v_and_b32_dpp v26, v9, v18 row_newbcast:12 row_mask:0xf bank_mask:0xf
    v_and_b32_dpp v27, v9, v19 row_newbcast:12 row_mask:0xf bank_mask:0xf
    s_nop 1
    v_mfma_f32_16x16x32_bf16 v[28:31], v[24:27], v[204:207], v[28:31]
    s_waitcnt vmcnt(11)
    v_and_b32_dpp v20, v9, v16 row_newbcast:2 row_mask:0xf bank_mask:0xf
    v_and_b32_dpp v21, v9, v17 row_newbcast:2 row_mask:0xf bank_mask:0xf
    v_and_b32_dpp v22, v9, v18 row_newbcast:2 row_mask:0xf bank_mask:0xf
    v_and_b32_dpp v23, v9, v19 row_newbcast:2 row_mask:0xf bank_mask:0xf
    s_nop 1
    v_mfma_f32_16x16x32_bf16 v[28:31], v[20:23], v[208:211], v[28:31]
    s_waitcnt vmcnt(10)
    v_and_b32_dpp v24, v9, v16 row_newbcast:10 row_mask:0xf bank_mask:0xf
    v_and_b32_dpp v25, v9, v17 row_newbcast:10 row_mask:0xf bank_mask:0xf
    v_and_b32_dpp v26, v9, v18 row_newbcast:10 row_mask:0xf bank_mask:0xf
    v_and_b32_dpp v27, v9, v19 row_newbcast:10 row_mask:0xf bank_mask:0xf
    s_nop 1
    v_mfma_f32_16x16x32_bf16 v[28:31], v[24:27], v[212:215], v[28:31]
    s_waitcnt vmcnt(9)
    v_and_b32_dpp v20, v9, v16 row_newbcast:6 row_mask:0xf bank_mask:0xf
    v_and_b32_dpp v21, v9, v17 row_newbcast:6 row_mask:0xf bank_mask:0xf
    v_and_b32_dpp v22, v9, v18 row_newbcast:6 row_mask:0xf bank_mask:0xf
    v_and_b32_dpp v23, v9, v19 row_newbcast:6 row_mask:0xf bank_mask:0xf
    s_nop 1
    v_mfma_f32_16x16x32_bf16 v[28:31], v[20:23], v[216:219], v[28:31]
    s_waitcnt vmcnt(8)
    v_and_b32_dpp v24, v9, v16 row_newbcast:14 row_mask:0xf bank_mask:0xf
    v_and_b32_dpp v25, v9, v17 row_newbcast:14 row_mask:0xf bank_mask:0xf
    v_and_b32_dpp v26, v9, v18 row_newbcast:14 row_mask:0xf bank_mask:0xf
    v_and_b32_dpp v27, v9, v19 row_newbcast:14 row_mask:0xf bank_mask:0xf
    s_nop 1
    v_mfma_f32_16x16x32_bf16 v[28:31], v[24:27], v[220:223], v[28:31]
    s_waitcnt vmcnt(7)
    v_and_b32_dpp v20, v9, v16 row_newbcast:1 row_mask:0xf bank_mask:0xf
    v_and_b32_dpp v21, v9, v17 row_newbcast:1 row_mask:0xf bank_mask:0xf
    v_and_b32_dpp v22, v9, v18 row_newbcast:1 row_mask:0xf bank_mask:0xf
    v_and_b32_dpp v23, v9, v19 row_newbcast:1 row_mask:0xf bank_mask:0xf
    s_nop 1
    v_mfma_f32_16x16x32_bf16 v[28:31], v[20:23], v[224:227], v[28:31]
    s_waitcnt vmcnt(6)
    v_and_b32_dpp v24, v9, v16 row_newbcast:9 row_mask:0xf bank_mask:0xf
    v_and_b32_dpp v25, v9, v17 row_newbcast:9 row_mask:0xf bank_mask:0xf
    v_and_b32_dpp v26, v9, v18 row_newbcast:9 row_mask:0xf bank_mask:0xf
    v_and_b32_dpp v27, v9, v19 row_newbcast:9 row_mask:0xf bank_mask:0xf
    s_nop 1
    v_mfma_f32_16x16x32_bf16 v[28:31], v[24:27], v[228:231], v[28:31]
    s_waitcnt vmcnt(5)
    v_and_b32_dpp v20, v9, v16 row_newbcast:5 row_mask:0xf bank_mask:0xf
    v_and_b32_dpp v21, v9, v17 row_newbcast:5 row_mask:0xf bank_mask:0xf
    v_and_b32_dpp v22, v9, v18 row_newbcast:5 row_mask:0xf bank_mask:0xf
    v_and_b32_dpp v23, v9, v19 row_newbcast:5 row_mask:0xf bank_mask:0xf
    s_nop 1
    v_mfma_f32_16x16x32_bf16 v[28:31], v[20:23], v[232:235], v[28:31]
    s_waitcnt vmcnt(4)
    v_and_b32_dpp v24, v9, v16 row_newbcast:13 row_mask:0xf bank_mask:0xf
    v_and_b32_dpp v25, v9, v17 row_newbcast:13 row_mask:0xf bank_mask:0xf
    v_and_b32_dpp v26, v9, v18 row_newbcast:13 row_mask:0xf bank_mask:0xf
    v_and_b32_dpp v27, v9, v19 row_newbcast:13 row_mask:0xf bank_mask:0xf
    s_nop 1
    v_mfma_f32_16x16x32_bf16 v[28:31], v[24:27], v[236:239], v[28:31]
    s_waitcnt vmcnt(3)
    v_and_b32_dpp v20, v9, v16 row_newbcast:3 row_mask:0xf bank_mask:0xf
    v_and_b32_dpp v21, v9, v17 row_newbcast:3 row_mask:0xf bank_mask:0xf
    v_and_b32_dpp v22, v9, v18 row_newbcast:3 row_mask:0xf bank_mask:0xf
    v_and_b32_dpp v23, v9, v19 row_newbcast:3 row_mask:0xf bank_mask:0xf
    s_nop 1
    v_mfma_f32_16x16x32_bf16 v[28:31], v[20:23], v[240:243], v[28:31]
    s_waitcnt vmcnt(2)
    v_and_b32_dpp v24, v9, v16 row_newbcast:11 row_mask:0xf bank_mask:0xf
    v_and_b32_dpp v25, v9, v17 row_newbcast:11 row_mask:0xf bank_mask:0xf
    v_and_b32_dpp v26, v9, v18 row_newbcast:11 row_mask:0xf bank_mask:0xf
    v_and_b32_dpp v27, v9, v19 row_newbcast:11 row_mask:0xf bank_mask:0xf
    s_nop 1
    v_mfma_f32_16x16x32_bf16 v[28:31], v[24:27], v[244:247], v[28:31]
    s_waitcnt vmcnt(1)
    v_and_b32_dpp v20, v9, v16 row_newbcast:7 row_mask:0xf bank_mask:0xf
    v_and_b32_dpp v21, v9, v17 row_newbcast:7 row_mask:0xf bank_mask:0xf
    v_and_b32_dpp v22, v9, v18 row_newbcast:7 row_mask:0xf bank_mask:0xf
    v_and_b32_dpp v23, v9, v19 row_newbcast:7 row_mask:0xf bank_mask:0xf
    s_nop 1
    v_mfma_f32_16x16x32_bf16 v[28:31], v[20:23], v[248:251], v[28:31]
    s_waitcnt vmcnt(0)
    v_and_b32_dpp v24, v9, v16 row_newbcast:15 row_mask:0xf bank_mask:0xf
    v_and_b32_dpp v25, v9, v17 row_newbcast:15 row_mask:0xf bank_mask:0xf
    v_and_b32_dpp v26, v9, v18 row_newbcast:15 row_mask:0xf bank_mask:0xf
    v_and_b32_dpp v27, v9, v19 row_newbcast:15 row_mask:0xf bank_mask:0xf
    s_nop 1
    v_mfma_f32_16x16x32_bf16 v[28:31], v[24:27], v[252:255], v[28:31]
    s_nop 7
    v_mul_f32 v28, s68, v28
    v_mul_f32 v29, s68, v29
    v_mul_f32 v30, s68, v30
    v_mul_f32 v31, s68, v31
    s_mov_b32 exec_hi, 0
    ds_write_b128 v46, v[28:31] offset:2048
    s_mov_b32 exec_hi, -1
    s_waitcnt lgkmcnt(0)
    s_barrier
    s_barrier
L_pub:
    s_cmp_ge_u32 s3, 3
    s_cbranch_scc1 L_nopub
    v_lshlrev_b32 v46, 4, v0
    ds_read_b128 v[64:67], v46 offset:4096
    ds_read_b128 v[68:71], v46 offset:6656
    ds_read_b128 v[72:75], v46 offset:9216
    ds_read_b128 v[76:79], v46 offset:11776
    s_mul_i32 s54, s34, 2560
    v_add_u32 v47, s54, v46
    v_mov_b32 v45, 0x7fff0000
    v_cmp_gt_u32 vcc, 160, v0
    s_nop 1
    v_cndmask_b32 v47, v45, v47, vcc
    s_waitcnt lgkmcnt(0)
    v_add_f32 v64, v64, v68
    v_add_f32 v72, v72, v76
    v_add_f32 v65, v65, v69
    v_add_f32 v73, v73, v77
    v_add_f32 v66, v66, v70
    v_add_f32 v74, v74, v78
    v_add_f32 v67, v67, v71
    v_add_f32 v75, v75, v79
    v_add_f32 v64, v64, v72
    v_add_f32 v65, v65, v73
    v_add_f32 v66, v66, v74
    v_add_f32 v67, v67, v75
    v_min_u32 v64, 0xfffffffe, v64
    v_min_u32 v65, 0xfffffffe, v65
    v_min_u32 v66, 0xfffffffe, v66
    v_min_u32 v67, 0xfffffffe, v67
    buffer_store_dwordx4 v[64:67], v47, s[40:43], 0 offen sc1
L_nopub:
    s_cmp_ge_u32 s2, 80
    s_cbranch_scc1 L_fin
    s_cmp_ge_u32 s2, 40
    s_cselect_b32 s54, 1, 0
    s_mul_i32 s55, s54, 40
    s_sub_u32 s55, s2, s55
    v_lshrrev_b32 v44, 2, v0
    v_and_b32 v45, 3, v0
    s_lshl_b32 s56, s55, 6
    v_lshl_add_u32 v45, v45, 4, s56
    s_mul_i32 s56, s54, 327680
    v_mul_u32_u24 v46, 2560, v44
    v_add3_u32 v46, v46, v45, s56
    s_mov_b32 s49, 0
L_g:
    buffer_load_dwordx4 v[48:51], v46, s[40:43], 0 offen sc1
    s_add_u32 s49, s49, 1
    s_waitcnt vmcnt(0)
    v_max_u32 v56, v48, v49
    v_max3_u32 v56, v56, v50, v51
    v_cmp_eq_u32 vcc, -1, v56
    s_cmp_ge_u32 s49, 65536
    s_cbranch_scc1 L_g_done
    s_and_b64 exec, exec, vcc
    s_cbranch_execnz L_g
L_g_done:
    s_mov_b64 exec, -1
    v_add_f32_dpp v48, v48, v48 row_ror:8 row_mask:0xf bank_mask:0xf
    v_add_f32_dpp v49, v49, v49 row_ror:8 row_mask:0xf bank_mask:0xf
    v_add_f32_dpp v50, v50, v50 row_ror:8 row_mask:0xf bank_mask:0xf
    v_add_f32_dpp v51, v51, v51 row_ror:8 row_mask:0xf bank_mask:0xf
    v_add_f32_dpp v48, v48, v48 row_ror:4 row_mask:0xf bank_mask:0xf
    v_add_f32_dpp v49, v49, v49 row_ror:4 row_mask:0xf bank_mask:0xf
    v_add_f32_dpp v50, v50, v50 row_ror:4 row_mask:0xf bank_mask:0xf
    v_add_f32_dpp v51, v51, v51 row_ror:4 row_mask:0xf bank_mask:0xf
    v_lshlrev_b32 v44, 9, v3
    s_lshl_b32 s56, s3, 4
    v_lshl_add_u32 v45, v2, 2, s56
    v_add_u32 v44, v44, v45
    s_mov_b32 exec_lo, 0x000f000f
    s_mov_b32 exec_hi, 0x000f000f
    ds_write_b32 v44, v48 offset:0
    ds_write_b32 v44, v49 offset:128
    ds_write_b32 v44, v50 offset:256
    ds_write_b32 v44, v51 offset:384
    s_mov_b64 exec, -1
    s_waitcnt lgkmcnt(0)
    s_barrier
    s_cmp_eq_u32 s3, 0
    s_cbranch_scc0 L_fin
    v_lshlrev_b32 v44, 5, v1
    ds_read_b128 v[64:67], v44 offset:0
    ds_read_b128 v[68:71], v44 offset:16
    s_mov_b32 s64, s24
    s_mov_b32 s65, s25
    s_mov_b32 s66, 2560
    s_mov_b32 s67, 0x20000
    s_mul_i32 s56, s54, 1280
    s_lshl_b32 s57, s55, 5
    s_add_u32 s56, s56, s57
    v_lshrrev_b32 v61, 2, v1
    v_lshl_add_u32 v61, v61, 1, s56
    v_and_b32 v62, 3, v1
    v_mov_b32 v43, 0x7fff0000
    v_cmp_eq_u32 vcc, 0, v62
    s_nop 1
    v_cndmask_b32 v61, v43, v61, vcc
    s_waitcnt lgkmcnt(0)
    v_add_f32 v64, v64, v65
    v_add_f32 v66, v66, v67
    v_add_f32 v68, v68, v69
    v_add_f32 v70, v70, v71
    v_add_f32 v64, v64, v66
    v_add_f32 v68, v68, v70
    v_add_f32 v64, v64, v68
    s_nop 1
    v_add_f32_dpp v64, v64, v64 quad_perm:[1,0,3,2] row_mask:0xf bank_mask:0xf
    s_nop 1
    v_add_f32_dpp v64, v64, v64 quad_perm:[2,3,0,1] row_mask:0xf bank_mask:0xf
    v_cvt_pk_bf16_f32 v64, v64, v64
    buffer_store_short v64, v61, s[64:67], 0 offen
L_fin:
L_end:
    s_endpgm
.section .rodata,"a"
.p2align 6
.amdhsa_kernel gated_mix__mha_block_cached__swiglu_ffn__decode_kernel
  .amdhsa_next_free_vgpr 256
  .amdhsa_next_free_sgpr 100
  .amdhsa_accum_offset 256
  .amdhsa_group_segment_fixed_size 0
  .amdhsa_kernarg_size 104
  .amdhsa_user_sgpr_count 2
  .amdhsa_user_sgpr_kernarg_segment_ptr 1
  .amdhsa_system_sgpr_workgroup_id_x 1
  .amdhsa_float_denorm_mode_32 3
.end_amdhsa_kernel
```
